```python
import torch

def _softmax(x, axis=-1):
    return torch.softmax(x, dim=axis)
def _gelu(x):
    return torch.nn.functional.gelu(x, approximate="tanh")
def _silu(x):
    return torch.nn.functional.silu(x)
def _sigmoid(x):
    return torch.sigmoid(x)
def _layernorm(x, axis=-1, eps=1e-5):
    m = x.mean(dim=axis, keepdim=True)
    v = x.var(dim=axis, keepdim=True, unbiased=False)
    return (x - m) / torch.sqrt(v + eps)
def _scatter_add(tgt, idx, src, axis=0):
    return tgt.clone().index_add_(axis, idx, src)
def _segment_sum(src, seg, n):
    out = torch.zeros((n,) + src.shape[1:], dtype=src.dtype)
    return out.index_add_(0, seg, src)
def _pad(x, pw):
    flat = tuple(v for pair in reversed(pw) for v in pair)
    return torch.nn.functional.pad(x, flat)

kernel_name = 'standalone__gqa_softmax__near_ridge'

def setup_inputs():

    _w = (lambda a: (lambda t: t.to(torch.bfloat16) if t.is_floating_point() else t)(torch.as_tensor(a)))
    B, Hq, Hkv, Sq, Sk, D = 8, 16, 8, 192, 1024, 256
    return {
        "q": _w((lambda *s: torch.randn(*s, dtype=torch.bfloat16) * 0.8)(B, Hq, Sq, D)),
        "k": _w((lambda *s: torch.randn(*s, dtype=torch.bfloat16) * 0.8)(B, Hkv, Sk, D)),
        "v": _w((lambda *s: torch.randn(*s, dtype=torch.bfloat16) * 0.05)(B, Hkv, Sk, D)),
    }

def reference(q, k, v):
    B, Hq, Sq, D = q.shape
    Hkv = k.shape[1]
    rep = Hq // Hkv
    k = (lambda x, n, axis: torch.repeat_interleave(x, n, dim=axis))(k, rep, axis=1)
    v = (lambda x, n, axis: torch.repeat_interleave(x, n, dim=axis))(v, rep, axis=1)
    scale = D ** -0.5
    scores = torch.einsum("bhqd,bhkd->bhqk", q, k) * scale
    p = _softmax(scores, axis=-1)
    return torch.einsum("bhqk,bhkd->bhqd", p, v)
```

```asm
; @launch grid=(256,1,1) block=(256,1,1) lds=161792
.amdgcn_target "amdgcn-amd-amdhsa--gfx950"
.text
.globl standalone__gqa_softmax__near_ridge_kernel
.p2align 8
.type standalone__gqa_softmax__near_ridge_kernel,@function
standalone__gqa_softmax__near_ridge_kernel:
    s_cmp_ge_u32 s2, 256
    s_cbranch_scc1 L_end
    s_load_dwordx8 s[4:11], s[0:1], 0
    s_getpc_b64 s[76:77]
L_pc:
    v_lshlrev_b32 v240, 7, v0
    v_min_u32 v240, L_code_end - L_pc - 4, v240
    v_mov_b32 v241, s77
    v_add_co_u32 v240, vcc, s76, v240
    v_and_b32 v220, 63, v0
    v_lshrrev_b32 v221, 6, v0
    v_addc_co_u32 v241, vcc, 0, v241, vcc
    global_load_dword v223, v[240:241], off
    v_readfirstlane_b32 s28, v221
    s_and_b32 s30, s2, 7
    s_lshl_b32 s30, s30, 5
    s_lshr_b32 s76, s2, 3
    s_add_u32 s30, s30, s76
    v_lshrrev_b32 v229, 5, v220
    v_xor_b32 v229, v229, v220
    v_lshlrev_b32 v213, 4, v229
    s_mul_i32 s77, s30, 49152
    s_lshl_b32 s76, s28, 12
    s_add_u32 s76, s77, s76
    v_add_u32 v255, s76, v213
    s_movk_i32 s79, 96
    s_mul_i32 s76, s28, 4224
    s_add_u32 m0, s76, 133120
    s_mov_b32 s14, 12583008
    s_mov_b32 s15, 0x20000
    s_lshl_b32 s36, s76, 2
    s_lshr_b32 s78, s30, 2
    s_lshl_b32 s78, s78, 19
    s_waitcnt lgkmcnt(0)
    s_sub_u32 s12, s4, 96
    s_subb_u32 s13, s5, 0
    buffer_load_dwordx4 v255, s[12:15], s79 offen offset:0 nt lds
    s_and_b32 s83, s30, 1
    s_mul_i32 s83, s83, 0xa000
    s_lshl_b32 s76, s28, 14
    s_add_u32 s40, s76, 67584
    buffer_load_dwordx4 v255, s[12:15], 64 offen offset:1056 nt lds
    s_and_b32 s31, s83, 0xc000
    s_xor_b32 s76, s76, s31
    s_add_u32 s76, s76, s78
    v_add_u32 v213, s76, v213
    buffer_load_dwordx4 v255, s[12:15], 32 offen offset:2112 nt lds
    s_sub_u32 s16, s6, 4096
    s_subb_u32 s17, s7, 0
    s_add_u32 s18, s78, 528384
    s_mov_b32 s19, 0x20000
    buffer_load_dwordx4 v255, s[12:15], 0 offen offset:3168 nt lds
    s_and_b32 s31, s83, 0x3000
    s_mov_b32 m0, s36
    s_add_u32 s44, s31, 4096
    buffer_load_dwordx4 v213, s[16:19], s44 offen offset:0 lds
    s_add_u32 s45, s31, 4064
    buffer_load_dwordx4 v213, s[16:19], s45 offen offset:1056 lds
    s_add_u32 s46, s31, 4032
    buffer_load_dwordx4 v213, s[16:19], s46 offen offset:2112 lds
    s_add_u32 s47, s31, 4000
    buffer_load_dwordx4 v213, s[16:19], s47 offen offset:3168 lds
    s_add_u32 s37, s36, 4224
    s_xor_b32 s31, s31, 0x1000
    s_mov_b32 m0, s37
    s_add_u32 s48, s31, 4096
    buffer_load_dwordx4 v213, s[16:19], s48 offen offset:0 lds
    s_add_u32 s49, s31, 4064
    buffer_load_dwordx4 v213, s[16:19], s49 offen offset:1056 lds
    s_add_u32 s50, s31, 4032
    buffer_load_dwordx4 v213, s[16:19], s50 offen offset:2112 lds
    s_add_u32 s51, s31, 4000
    buffer_load_dwordx4 v213, s[16:19], s51 offen offset:3168 lds
    s_xor_b32 s31, s31, 12288
    s_add_u32 s38, s36, 8448
    s_add_u32 s52, s31, 4096
    s_add_u32 s53, s31, 4064
    s_add_u32 s54, s31, 4032
    s_add_u32 s55, s31, 4000
    s_xor_b32 s31, s31, 4096
    s_add_u32 s39, s36, 12672
    s_add_u32 s56, s31, 4096
    s_add_u32 s57, s31, 4064
    s_add_u32 s58, s31, 4032
    s_add_u32 s59, s31, 4000
    s_and_b32 s80, s28, 1
    s_lshl_b32 s80, s80, 7
    s_sub_u32 s80, s40, s80
    v_add_u32 v255, 0x4000, v255
    s_mov_b32 s6, 0x10000
    s_mov_b32 s7, s6
    s_mov_b32 s3, s6
    v_lshrrev_b32 v228, 3, v220
    v_lshlrev_b32 v228, 9, v228
    v_lshrrev_b32 v229, 4, v220
    v_and_b32 v230, 7, v220
    s_lshl_b32 s29, s28, 7
    s_add_u32 s77, s77, s29
    v_lshl_add_u32 v219, v230, 4, v228
    v_add_u32 v219, s77, v219
    v_lshlrev_b32 v229, 1, v229
    v_xor_b32 v231, v230, v229
    v_lshl_add_u32 v214, v231, 4, v228
    s_add_u32 s76, s29, s78
    v_add_u32 v214, s76, v214
    v_bfe_u32 v228, v220, 1, 3
    v_mul_u32_u24 v228, 1056, v228
    v_and_b32 v230, 1, v220
    s_mov_b32 m0, s38
    s_nop 0
    buffer_load_dwordx4 v213, s[16:19], s52 offen offset:0 lds
    v_lshl_add_u32 v228, v230, 9, v228
    v_lshrrev_b32 v229, 4, v220
    v_xor_b32 v230, v230, v229
    v_lshl_add_u32 v228, v230, 4, v228
    v_bfe_u32 v230, v220, 3, 1
    v_mul_u32_u24 v230, 12032, v230
    v_add_u32 v221, 67584, v228
    v_add_u32 v221, v221, v230
    v_add_u32 v222, 133120, v228
    v_add_u32 v210, s36, v228
    v_and_b32 v228, 15, v220
    v_lshlrev_b32 v228, 4, v228
    v_add_u32 v216, 157696, v228
    v_lshrrev_b32 v230, 5, v220
    v_lshl_add_u32 v230, v230, 8, v216
    s_lshl_b32 s76, s28, 2
    buffer_load_dwordx4 v213, s[16:19], s53 offen offset:1056 lds
    v_add_u32 v215, s76, v230
    v_mov_b32 v217, 1024
    v_mov_b32 v218, 0
    ds_write_b32 v217, v218
    s_mov_b32 s32, 0x3db8aa3b
    s_mov_b32 s33, 0x47800000
    s_mov_b32 s31, 0
    s_add_u32 s41, s40, 4096
    s_add_u32 s42, s40, 8192
    s_add_u32 s43, s40, 12288
    s_sub_u32 s20, s8, 4096
    s_subb_u32 s21, s9, 0
    s_mov_b32 s22, s18
    s_mov_b32 s23, 0x20000
    s_xor_b32 s76, s83, 0
    s_add_u32 s60, s76, 4096
    buffer_load_dwordx4 v213, s[16:19], s54 offen offset:2112 lds
    s_add_u32 s61, s76, 7168
    s_add_u32 s64, s76, 20480
    s_add_u32 s65, s76, 23552
    s_xor_b32 s76, s83, 8192
    s_add_u32 s62, s76, 2048
    s_add_u32 s63, s76, 5120
    s_add_u32 s66, s76, 18432
    s_add_u32 s67, s76, 21504
    s_xor_b32 s76, s83, 32768
    s_add_u32 s68, s76, 4096
    s_add_u32 s69, s76, 7168
    s_add_u32 s72, s76, 20480
    s_add_u32 s73, s76, 23552
    s_xor_b32 s76, s83, 40960
    s_add_u32 s70, s76, 2048
    s_add_u32 s71, s76, 5120
    buffer_load_dwordx4 v213, s[16:19], s55 offen offset:3168 lds
    s_add_u32 s74, s76, 18432
    s_add_u32 s75, s76, 21504
    s_mov_b32 s24, s10
    s_mov_b32 s25, s11
    s_mov_b32 s26, 12582912
    s_mov_b32 s27, 0x20000
    v_lshrrev_b32 v228, 2, v220
    v_lshlrev_b32 v228, 7, v228
    v_bfe_u32 v230, v220, 3, 2
    v_lshl_add_u32 v228, v230, 5, v228
    v_and_b32 v230, 3, v220
    v_lshl_add_u32 v228, v230, 3, v228
    v_add_u32 v224, s40, v228
    v_xor_b32 v225, 32, v224
    v_xor_b32 v226, 64, v224
    v_xor_b32 v227, 96, v224
    s_mov_b32 m0, s39
    s_nop 0
    buffer_load_dwordx4 v213, s[16:19], s56 offen offset:0 lds
    v_lshlrev_b32 v228, 4, v220
    v_add_u32 v211, 133120, v228
    s_mul_i32 s76, s28, 6144
    v_add_u32 v212, s76, v211
    v_mov_b32 v0, 0
    v_mov_b32 v1, 0
    v_mov_b32 v2, 0
    v_mov_b32 v3, 0
    v_mov_b32 v4, 0
    v_mov_b32 v5, 0
    v_mov_b32 v6, 0
    v_mov_b32 v7, 0
    v_mov_b32 v8, 0
    v_mov_b32 v9, 0
    v_mov_b32 v10, 0
    v_mov_b32 v11, 0
    buffer_load_dwordx4 v213, s[16:19], s57 offen offset:1056 lds
    v_mov_b32 v12, 0
    v_mov_b32 v13, 0
    v_mov_b32 v14, 0
    v_mov_b32 v15, 0
    v_mov_b32 v16, 0
    v_mov_b32 v17, 0
    v_mov_b32 v18, 0
    v_mov_b32 v19, 0
    v_mov_b32 v20, 0
    v_mov_b32 v21, 0
    v_mov_b32 v22, 0
    v_mov_b32 v23, 0
    v_mov_b32 v24, 0
    v_mov_b32 v25, 0
    v_mov_b32 v26, 0
    v_mov_b32 v27, 0
    buffer_load_dwordx4 v213, s[16:19], s58 offen offset:2112 lds
    v_mov_b32 v28, 0
    v_mov_b32 v29, 0
    v_mov_b32 v30, 0
    v_mov_b32 v31, 0
    v_mov_b32 v32, 0
    v_mov_b32 v33, 0
    v_mov_b32 v34, 0
    v_mov_b32 v35, 0
    v_mov_b32 v36, 0
    v_mov_b32 v37, 0
    v_mov_b32 v38, 0
    v_mov_b32 v39, 0
    v_mov_b32 v40, 0
    v_mov_b32 v41, 0
    v_mov_b32 v42, 0
    v_mov_b32 v43, 0
    buffer_load_dwordx4 v213, s[16:19], s59 offen offset:3168 lds
    v_add_u32 v213, s6, v213
    v_mov_b32 v44, 0
    v_mov_b32 v45, 0
    v_mov_b32 v46, 0
    v_mov_b32 v47, 0
    v_mov_b32 v48, 0
    v_mov_b32 v49, 0
    v_mov_b32 v50, 0
    v_mov_b32 v51, 0
    v_mov_b32 v52, 0
    v_mov_b32 v53, 0
    v_mov_b32 v54, 0
    v_mov_b32 v55, 0
    v_mov_b32 v56, 0
    v_mov_b32 v57, 0
    v_mov_b32 v58, 0
    v_mov_b32 v59, 0
    s_add_u32 m0, s80, 7936
    s_nop 0
    buffer_load_dwordx4 v255, s[12:15], s79 offen offset:0 nt lds
    v_mov_b32 v60, 0
    v_mov_b32 v61, 0
    v_mov_b32 v62, 0
    v_mov_b32 v63, 0
    v_mov_b32 v64, 0
    v_mov_b32 v65, 0
    v_mov_b32 v66, 0
    v_mov_b32 v67, 0
    v_mov_b32 v68, 0
    v_mov_b32 v69, 0
    v_mov_b32 v70, 0
    v_mov_b32 v71, 0
    v_mov_b32 v72, 0
    v_mov_b32 v73, 0
    v_mov_b32 v74, 0
    v_mov_b32 v75, 0
    buffer_load_dwordx4 v255, s[12:15], 64 offen offset:1056 nt lds
    v_mov_b32 v76, 0
    v_mov_b32 v77, 0
    v_mov_b32 v78, 0
    v_mov_b32 v79, 0
    v_mov_b32 v80, 0
    v_mov_b32 v81, 0
    v_mov_b32 v82, 0
    v_mov_b32 v83, 0
    v_mov_b32 v84, 0
    v_mov_b32 v85, 0
    v_mov_b32 v86, 0
    v_mov_b32 v87, 0
    v_mov_b32 v88, 0
    v_mov_b32 v89, 0
    v_mov_b32 v90, 0
    v_mov_b32 v91, 0
    buffer_load_dwordx4 v255, s[12:15], 32 offen offset:2112 nt lds
    v_mov_b32 v92, 0
    v_mov_b32 v93, 0
    v_mov_b32 v94, 0
    v_mov_b32 v95, 0
    v_mov_b32 v198, 0
    v_mov_b32 v199, 0
    v_mov_b32 v200, 0
    v_mov_b32 v201, 0
    v_mov_b32 v202, 0
    v_mov_b32 v203, 0
    buffer_load_dwordx4 v255, s[12:15], 0 offen offset:3168 nt lds
    v_add_u32 v255, 0x4000, v255
    s_waitcnt lgkmcnt(0)
    s_waitcnt vmcnt(20)
    s_barrier
    s_waitcnt vmcnt(12)
    ds_read_b128 a[192:195], v210 offset:0
    ds_read_b128 a[0:3], v222 offset:0
    ds_read_b128 a[196:199], v210 offset:64
    ds_read_b128 a[4:7], v222 offset:64
    ds_read_b128 a[200:203], v210 offset:128
    ds_read_b128 a[8:11], v222 offset:128
    ds_read_b128 a[204:207], v210 offset:192
    ds_read_b128 a[12:15], v222 offset:192
    ds_read_b128 a[208:211], v210 offset:256
    ds_read_b128 a[16:19], v222 offset:256
    ds_read_b128 a[212:215], v210 offset:320
    ds_read_b128 a[20:23], v222 offset:320
    ds_read_b128 a[216:219], v210 offset:384
    ds_read_b128 a[24:27], v222 offset:384
    ds_read_b128 a[220:223], v210 offset:448
    ds_read_b128 a[28:31], v222 offset:448
    s_waitcnt lgkmcnt(14)
    v_mfma_f32_16x16x32_bf16 v[96:99], a[192:195], a[0:3], 0
    s_add_u32 m0, s80, 12160
    ds_read_b128 a[32:35], v222 offset:8448
    ds_read_b128 a[36:39], v222 offset:8512
    s_waitcnt lgkmcnt(14)
    v_mfma_f32_16x16x32_bf16 v[96:99], a[196:199], a[4:7], v[96:99]
    buffer_load_dwordx4 v255, s[12:15], s79 offen offset:0 nt lds
    s_waitcnt lgkmcnt(12)
    v_mfma_f32_16x16x32_bf16 v[96:99], a[200:203], a[8:11], v[96:99]
    ds_read_b128 a[40:43], v222 offset:8576
    ds_read_b128 a[44:47], v222 offset:8640
    s_waitcnt lgkmcnt(12)
    v_mfma_f32_16x16x32_bf16 v[96:99], a[204:207], a[12:15], v[96:99]
    s_waitcnt lgkmcnt(4)
    ds_read_b128 a[48:51], v222 offset:8704
    ds_read_b128 a[52:55], v222 offset:8768
    v_mfma_f32_16x16x32_bf16 v[96:99], a[208:211], a[16:19], v[96:99]
    ds_read_b128 a[56:59], v222 offset:8832
    ds_read_b128 a[60:63], v222 offset:8896
    v_mfma_f32_16x16x32_bf16 v[96:99], a[212:215], a[20:23], v[96:99]
    buffer_load_dwordx4 v255, s[12:15], 64 offen offset:1056 nt lds
    v_mfma_f32_16x16x32_bf16 v[96:99], a[216:219], a[24:27], v[96:99]
    s_waitcnt vmcnt(6)
    ds_read_b128 a[224:227], v210 offset:8448
    ds_read_b128 a[228:231], v210 offset:8512
    v_mfma_f32_16x16x32_bf16 v[96:99], a[220:223], a[28:31], v[96:99]
    s_waitcnt lgkmcnt(6)
    ds_read_b128 a[232:235], v210 offset:8576
    ds_read_b128 a[236:239], v210 offset:8640
    v_mfma_f32_16x16x32_bf16 v[104:107], a[192:195], a[32:35], 0
    ds_read_b128 a[240:243], v210 offset:8704
    ds_read_b128 a[244:247], v210 offset:8768
    v_mfma_f32_16x16x32_bf16 v[104:107], a[196:199], a[36:39], v[104:107]
    buffer_load_dwordx4 v255, s[12:15], 32 offen offset:2112 nt lds
    v_mfma_f32_16x16x32_bf16 v[104:107], a[200:203], a[40:43], v[104:107]
    ds_read_b128 a[248:251], v210 offset:8832
    ds_read_b128 a[252:255], v210 offset:8896
    v_mfma_f32_16x16x32_bf16 v[104:107], a[204:207], a[44:47], v[104:107]
    s_waitcnt lgkmcnt(8)
    v_max3_f32 v240, v96, v97, v98
    v_mfma_f32_16x16x32_bf16 v[104:107], a[208:211], a[48:51], v[104:107]
    v_max_f32 v240, v240, v99
    v_mfma_f32_16x16x32_bf16 v[104:107], a[212:215], a[52:55], v[104:107]
    buffer_load_dwordx4 v255, s[12:15], 0 offen offset:3168 nt lds
    v_mfma_f32_16x16x32_bf16 v[104:107], a[216:219], a[56:59], v[104:107]
    v_mfma_f32_16x16x32_bf16 v[104:107], a[220:223], a[60:63], v[104:107]
    s_waitcnt lgkmcnt(4)
    v_mfma_f32_16x16x32_bf16 v[100:103], a[224:227], a[0:3], 0
    v_mfma_f32_16x16x32_bf16 v[100:103], a[228:231], a[4:7], v[100:103]
    s_mov_b32 m0, s36
    v_mfma_f32_16x16x32_bf16 v[100:103], a[232:235], a[8:11], v[100:103]
    buffer_load_dwordx4 v213, s[16:19], s44 offen offset:0 lds
    v_mfma_f32_16x16x32_bf16 v[100:103], a[236:239], a[12:15], v[100:103]
    s_waitcnt lgkmcnt(0)
    v_max3_f32 v241, v104, v105, v106
    v_mfma_f32_16x16x32_bf16 v[100:103], a[240:243], a[16:19], v[100:103]
    v_max_f32 v241, v241, v107
    v_mfma_f32_16x16x32_bf16 v[100:103], a[244:247], a[20:23], v[100:103]
    v_mfma_f32_16x16x32_bf16 v[100:103], a[248:251], a[24:27], v[100:103]
    buffer_load_dwordx4 v213, s[16:19], s45 offen offset:1056 lds
    v_permlane32_swap_b32 v240, v241
    v_mfma_f32_16x16x32_bf16 v[100:103], a[252:255], a[28:31], v[100:103]
    v_max_f32 v240, v240, v241
    v_mfma_f32_16x16x32_bf16 v[108:111], a[224:227], a[32:35], 0
    v_mov_b32 v242, v240
    v_mfma_f32_16x16x32_bf16 v[108:111], a[228:231], a[36:39], v[108:111]
    v_mfma_f32_16x16x32_bf16 v[108:111], a[232:235], a[40:43], v[108:111]
    buffer_load_dwordx4 v213, s[16:19], s46 offen offset:2112 lds
    v_permlane16_swap_b32 v240, v242
    v_mfma_f32_16x16x32_bf16 v[108:111], a[236:239], a[44:47], v[108:111]
    v_max_f32 v240, v240, v242
    v_mfma_f32_16x16x32_bf16 v[108:111], a[240:243], a[48:51], v[108:111]
    v_mul_f32 v240, s32, v240
    v_mfma_f32_16x16x32_bf16 v[108:111], a[244:247], a[52:55], v[108:111]
    ds_write_b32 v215, v240 offset:0
    v_mfma_f32_16x16x32_bf16 v[108:111], a[248:251], a[56:59], v[108:111]
    buffer_load_dwordx4 v213, s[16:19], s47 offen offset:3168 lds
    v_mfma_f32_16x16x32_bf16 v[108:111], a[252:255], a[60:63], v[108:111]
    s_waitcnt vmcnt(8) lgkmcnt(0)
    s_barrier
    ds_read_b128 v[244:247], v216 offset:0
    ds_read_b128 v[248:251], v216 offset:256
    ds_read_b128 a[64:67], v221 offset:7936
    ds_read_b128 a[68:71], v221 offset:8000
    ds_read_b128 a[72:75], v221 offset:8064
    ds_read_b128 a[76:79], v221 offset:8128
    ds_read_b128 a[80:83], v221 offset:8192
    ds_read_b128 a[84:87], v221 offset:8256
    ds_read_b128 a[88:91], v221 offset:8320
    ds_read_b128 a[92:95], v221 offset:8384
    s_waitcnt lgkmcnt(9)
    v_max3_f32 v244, v244, v245, v246
    s_waitcnt lgkmcnt(8)
    v_max3_f32 v248, v248, v249, v250
    v_max_f32 v192, v244, v247
    v_max_f32 v193, v248, v251
    s_waitcnt lgkmcnt(7)
    v_mfma_f32_16x16x32_bf16 v[112:115], a[192:195], a[64:67], 0
    s_mov_b32 m0, s37
    ds_read_b128 a[96:99], v221 offset:40704
    ds_read_b128 a[100:103], v221 offset:40768
    v_fma_f32 v228, v96, s32, -v192
    v_fma_f32 v229, v97, s32, -v192
    s_waitcnt lgkmcnt(8)
    v_mfma_f32_16x16x32_bf16 v[112:115], a[196:199], a[68:71], v[112:115]
    buffer_load_dwordx4 v213, s[16:19], s48 offen offset:0 lds
    v_exp_f32 v228, v228
    s_waitcnt lgkmcnt(7)
    v_mfma_f32_16x16x32_bf16 v[112:115], a[200:203], a[72:75], v[112:115]
    ds_read_b128 a[104:107], v221 offset:40832
    ds_read_b128 a[108:111], v221 offset:40896
    v_exp_f32 v229, v229
    s_waitcnt lgkmcnt(8)
    v_mfma_f32_16x16x32_bf16 v[112:115], a[204:207], a[76:79], v[112:115]
    s_waitcnt lgkmcnt(4)
    ds_read_b128 a[112:115], v221 offset:40960
    ds_read_b128 a[116:119], v221 offset:41024
    v_fma_f32 v230, v98, s32, -v192
    v_fma_f32 v231, v99, s32, -v192
    v_mfma_f32_16x16x32_bf16 v[112:115], a[208:211], a[80:83], v[112:115]
    ds_read_b128 a[120:123], v221 offset:41088
    ds_read_b128 a[124:127], v221 offset:41152
    v_exp_f32 v230, v230
    v_mfma_f32_16x16x32_bf16 v[112:115], a[212:215], a[84:87], v[112:115]
    buffer_load_dwordx4 v213, s[16:19], s49 offen offset:1056 lds
    v_exp_f32 v231, v231
    v_mfma_f32_16x16x32_bf16 v[112:115], a[216:219], a[88:91], v[112:115]
    v_add_f32 v204, v228, v229
    v_cvt_pk_bf16_f32 v144, v228, v229
    v_fma_f32 v232, v100, s32, -v192
    v_fma_f32 v233, v101, s32, -v192
    v_mfma_f32_16x16x32_bf16 v[112:115], a[220:223], a[92:95], v[112:115]
    s_waitcnt lgkmcnt(4)
    v_exp_f32 v232, v232
    v_exp_f32 v233, v233
    v_mfma_f32_16x16x32_bf16 v[120:123], a[192:195], a[96:99], 0
    v_add_f32 v204, v204, v230
    v_cvt_pk_bf16_f32 v145, v230, v231
    v_fma_f32 v234, v102, s32, -v192
    v_fma_f32 v235, v103, s32, -v192
    v_mfma_f32_16x16x32_bf16 v[120:123], a[196:199], a[100:103], v[120:123]
    buffer_load_dwordx4 v213, s[16:19], s50 offen offset:2112 lds
    v_exp_f32 v234, v234
    v_mfma_f32_16x16x32_bf16 v[120:123], a[200:203], a[104:107], v[120:123]
    v_exp_f32 v235, v235
    v_add_f32 v204, v204, v231
    v_cvt_pk_bf16_f32 v146, v232, v233
    v_mfma_f32_16x16x32_bf16 v[120:123], a[204:207], a[108:111], v[120:123]
    s_waitcnt lgkmcnt(0)
    v_max3_f32 v240, v112, v113, v114
    v_add_f32 v204, v204, v232
    v_fma_f32 v236, v104, s32, -v193
    v_mfma_f32_16x16x32_bf16 v[120:123], a[208:211], a[112:115], v[120:123]
    v_max_f32 v240, v240, v115
    v_exp_f32 v236, v236
    v_mfma_f32_16x16x32_bf16 v[120:123], a[212:215], a[116:119], v[120:123]
    buffer_load_dwordx4 v213, s[16:19], s51 offen offset:3168 lds
    v_add_f32 v204, v204, v233
    v_mfma_f32_16x16x32_bf16 v[120:123], a[216:219], a[120:123], v[120:123]
    v_add_f32 v204, v204, v234
    v_fma_f32 v237, v105, s32, -v193
    v_cvt_pk_bf16_f32 v147, v234, v235
    v_mfma_f32_16x16x32_bf16 v[120:123], a[220:223], a[124:127], v[120:123]
    v_exp_f32 v237, v237
    v_add_f32 v204, v204, v235
    v_mfma_f32_16x16x32_bf16 v[116:119], a[224:227], a[64:67], 0
    v_fma_f32 v238, v106, s32, -v193
    v_fma_f32 v239, v107, s32, -v193
    v_add_f32 v205, v236, v237
    v_mfma_f32_16x16x32_bf16 v[116:119], a[228:231], a[68:71], v[116:119]
    s_mov_b32 m0, s38
    v_exp_f32 v238, v238
    v_cvt_pk_bf16_f32 v148, v236, v237
    v_mfma_f32_16x16x32_bf16 v[116:119], a[232:235], a[72:75], v[116:119]
    buffer_load_dwordx4 v213, s[16:19], s52 offen offset:0 lds
    v_fma_f32 v228, v108, s32, -v193
    v_mfma_f32_16x16x32_bf16 v[116:119], a[236:239], a[76:79], v[116:119]
    v_max3_f32 v241, v120, v121, v122
    v_exp_f32 v239, v239
    v_mfma_f32_16x16x32_bf16 v[116:119], a[240:243], a[80:83], v[116:119]
    v_max_f32 v241, v241, v123
    v_exp_f32 v228, v228
    v_mfma_f32_16x16x32_bf16 v[116:119], a[244:247], a[84:87], v[116:119]
    v_add_f32 v205, v205, v238
    v_fma_f32 v229, v109, s32, -v193
    v_cvt_pk_bf16_f32 v149, v238, v239
    v_mfma_f32_16x16x32_bf16 v[116:119], a[248:251], a[88:91], v[116:119]
    buffer_load_dwordx4 v213, s[16:19], s53 offen offset:1056 lds
    v_permlane32_swap_b32 v240, v241
    v_mfma_f32_16x16x32_bf16 v[116:119], a[252:255], a[92:95], v[116:119]
    v_max_f32 v240, v240, v241
    v_exp_f32 v229, v229
    v_mfma_f32_16x16x32_bf16 v[124:127], a[224:227], a[96:99], 0
    v_mov_b32 v242, v240
    v_add_f32 v205, v205, v239
    v_fma_f32 v230, v110, s32, -v193
    v_mfma_f32_16x16x32_bf16 v[124:127], a[228:231], a[100:103], v[124:127]
    v_exp_f32 v230, v230
    v_add_f32 v205, v205, v228
    v_mfma_f32_16x16x32_bf16 v[124:127], a[232:235], a[104:107], v[124:127]
    buffer_load_dwordx4 v213, s[16:19], s54 offen offset:2112 lds
    v_permlane16_swap_b32 v240, v242
    v_mfma_f32_16x16x32_bf16 v[124:127], a[236:239], a[108:111], v[124:127]
    v_max_f32 v240, v240, v242
    v_fma_f32 v231, v111, s32, -v193
    v_add_f32 v205, v205, v229
    v_mfma_f32_16x16x32_bf16 v[124:127], a[240:243], a[112:115], v[124:127]
    v_mul_f32 v240, s32, v240
    v_exp_f32 v231, v231
    v_mfma_f32_16x16x32_bf16 v[124:127], a[244:247], a[116:119], v[124:127]
    ds_write_b32 v215, v240 offset:512
    v_cvt_pk_bf16_f32 v150, v228, v229
    v_add_f32 v205, v205, v230
    v_cvt_pk_bf16_f32 v151, v230, v231
    v_mfma_f32_16x16x32_bf16 v[124:127], a[248:251], a[120:123], v[124:127]
    buffer_load_dwordx4 v213, s[16:19], s55 offen offset:3168 lds
    v_add_f32 v205, v205, v231
    v_mfma_f32_16x16x32_bf16 v[124:127], a[252:255], a[124:127], v[124:127]
    s_waitcnt vmcnt(12) lgkmcnt(0)
    s_barrier
    ds_read_b128 v[244:247], v216 offset:512
    ds_read_b128 v[248:251], v216 offset:768
    ds_read_b128 a[128:131], v221 offset:12160
    ds_read_b128 a[132:135], v221 offset:12224
    ds_read_b128 a[136:139], v221 offset:12288
    ds_read_b128 a[140:143], v221 offset:12352
    ds_read_b128 a[144:147], v221 offset:12416
    ds_read_b128 a[148:151], v221 offset:12480
    ds_read_b128 a[152:155], v221 offset:12544
    ds_read_b128 a[156:159], v221 offset:12608
    s_waitcnt lgkmcnt(9)
    v_max3_f32 v244, v244, v245, v246
    s_waitcnt lgkmcnt(8)
    v_max3_f32 v248, v248, v249, v250
    v_max_f32 v194, v244, v247
    v_max_f32 v195, v248, v251
    s_waitcnt lgkmcnt(7)
    v_mfma_f32_16x16x32_bf16 v[128:131], a[192:195], a[128:131], 0
    s_mov_b32 m0, s39
    ds_read_b128 a[160:163], v221 offset:44928
    ds_read_b128 a[164:167], v221 offset:44992
    v_fma_f32 v228, v112, s32, -v194
    v_fma_f32 v229, v113, s32, -v194
    s_waitcnt lgkmcnt(8)
    v_mfma_f32_16x16x32_bf16 v[128:131], a[196:199], a[132:135], v[128:131]
    buffer_load_dwordx4 v213, s[16:19], s56 offen offset:0 lds
    v_exp_f32 v228, v228
    s_waitcnt lgkmcnt(7)
    v_mfma_f32_16x16x32_bf16 v[128:131], a[200:203], a[136:139], v[128:131]
    ds_read_b128 a[168:171], v221 offset:45056
    ds_read_b128 a[172:175], v221 offset:45120
    v_exp_f32 v229, v229
    s_waitcnt lgkmcnt(8)
    v_mfma_f32_16x16x32_bf16 v[128:131], a[204:207], a[140:143], v[128:131]
    s_waitcnt lgkmcnt(4)
    ds_read_b128 a[176:179], v221 offset:45184
    ds_read_b128 a[180:183], v221 offset:45248
    v_fma_f32 v230, v114, s32, -v194
    v_fma_f32 v231, v115, s32, -v194
    v_mfma_f32_16x16x32_bf16 v[128:131], a[208:211], a[144:147], v[128:131]
    ds_read_b128 a[184:187], v221 offset:45312
    ds_read_b128 a[188:191], v221 offset:45376
    v_exp_f32 v230, v230
    v_mfma_f32_16x16x32_bf16 v[128:131], a[212:215], a[148:151], v[128:131]
    buffer_load_dwordx4 v213, s[16:19], s57 offen offset:1056 lds
    v_exp_f32 v231, v231
    v_mfma_f32_16x16x32_bf16 v[128:131], a[216:219], a[152:155], v[128:131]
    v_add_f32 v206, v228, v229
    v_cvt_pk_bf16_f32 v152, v228, v229
    v_fma_f32 v232, v116, s32, -v194
    v_fma_f32 v233, v117, s32, -v194
    v_mfma_f32_16x16x32_bf16 v[128:131], a[220:223], a[156:159], v[128:131]
    s_waitcnt lgkmcnt(4)
    v_exp_f32 v232, v232
    v_exp_f32 v233, v233
    v_mfma_f32_16x16x32_bf16 v[136:139], a[192:195], a[160:163], 0
    v_add_f32 v206, v206, v230
    v_cvt_pk_bf16_f32 v153, v230, v231
    v_fma_f32 v234, v118, s32, -v194
    v_fma_f32 v235, v119, s32, -v194
    v_mfma_f32_16x16x32_bf16 v[136:139], a[196:199], a[164:167], v[136:139]
    buffer_load_dwordx4 v213, s[16:19], s58 offen offset:2112 lds
    v_exp_f32 v234, v234
    v_mfma_f32_16x16x32_bf16 v[136:139], a[200:203], a[168:171], v[136:139]
    v_exp_f32 v235, v235
    v_add_f32 v206, v206, v231
    v_cvt_pk_bf16_f32 v154, v232, v233
    v_mfma_f32_16x16x32_bf16 v[136:139], a[204:207], a[172:175], v[136:139]
    s_waitcnt lgkmcnt(0)
    v_max3_f32 v240, v128, v129, v130
    v_add_f32 v206, v206, v232
    v_fma_f32 v236, v120, s32, -v195
    v_mfma_f32_16x16x32_bf16 v[136:139], a[208:211], a[176:179], v[136:139]
    v_max_f32 v240, v240, v131
    v_exp_f32 v236, v236
    v_mfma_f32_16x16x32_bf16 v[136:139], a[212:215], a[180:183], v[136:139]
    buffer_load_dwordx4 v213, s[16:19], s59 offen offset:3168 lds
    v_add_u32 v213, s3, v213
    v_mfma_f32_16x16x32_bf16 v[136:139], a[216:219], a[184:187], v[136:139]
    v_add_f32 v206, v206, v233
    v_fma_f32 v237, v121, s32, -v195
    v_cvt_pk_bf16_f32 v155, v234, v235
    v_mfma_f32_16x16x32_bf16 v[136:139], a[220:223], a[188:191], v[136:139]
    v_exp_f32 v237, v237
    v_add_f32 v206, v206, v234
    v_mfma_f32_16x16x32_bf16 v[132:135], a[224:227], a[128:131], 0
    v_add_f32 v206, v206, v235
    v_fma_f32 v238, v122, s32, -v195
    v_fma_f32 v239, v123, s32, -v195
    v_mfma_f32_16x16x32_bf16 v[132:135], a[228:231], a[132:135], v[132:135]
    s_mov_b32 m0, s40
    v_exp_f32 v238, v238
    v_add_f32 v207, v236, v237
    v_mfma_f32_16x16x32_bf16 v[132:135], a[232:235], a[136:139], v[132:135]
    buffer_load_dwordx4 v214, s[20:23], s60 offen offset:0 lds
    v_cvt_pk_bf16_f32 v156, v236, v237
    v_mfma_f32_16x16x32_bf16 v[132:135], a[236:239], a[140:143], v[132:135]
    v_max3_f32 v241, v136, v137, v138
    v_exp_f32 v239, v239
    v_mfma_f32_16x16x32_bf16 v[132:135], a[240:243], a[144:147], v[132:135]
    v_max_f32 v241, v241, v139
    v_fma_f32 v228, v124, s32, -v195
    v_add_f32 v207, v207, v238
    v_mfma_f32_16x16x32_bf16 v[132:135], a[244:247], a[148:151], v[132:135]
    v_exp_f32 v228, v228
    v_fma_f32 v229, v125, s32, -v195
    v_mfma_f32_16x16x32_bf16 v[132:135], a[248:251], a[152:155], v[132:135]
    buffer_load_dwordx4 v214, s[20:23], s61 offen offset:1024 lds
    v_add_f32 v207, v207, v239
    v_mfma_f32_16x16x32_bf16 v[132:135], a[252:255], a[156:159], v[132:135]
    v_exp_f32 v229, v229
    v_cvt_pk_bf16_f32 v157, v238, v239
    v_mfma_f32_16x16x32_bf16 v[140:143], a[224:227], a[160:163], 0
    v_fma_f32 v230, v126, s32, -v195
    v_add_f32 v207, v207, v228
    v_fma_f32 v231, v127, s32, -v195
    v_mfma_f32_16x16x32_bf16 v[140:143], a[228:231], a[164:167], v[140:143]
    v_exp_f32 v230, v230
    v_add_f32 v207, v207, v229
    v_mfma_f32_16x16x32_bf16 v[140:143], a[232:235], a[168:171], v[140:143]
    buffer_load_dwordx4 v214, s[20:23], s62 offen offset:2048 lds
    v_cvt_pk_bf16_f32 v158, v228, v229
    v_mfma_f32_16x16x32_bf16 v[140:143], a[236:239], a[172:175], v[140:143]
    v_max3_f32 v240, v240, v132, v133
    v_exp_f32 v231, v231
    v_mfma_f32_16x16x32_bf16 v[140:143], a[240:243], a[176:179], v[140:143]
    v_max3_f32 v240, v240, v134, v135
    v_add_f32 v207, v207, v230
    v_cvt_pk_bf16_f32 v159, v230, v231
    v_mfma_f32_16x16x32_bf16 v[140:143], a[244:247], a[180:183], v[140:143]
    v_add_f32 v207, v207, v231
    v_max3_f32 v252, v204, v205, v206
    v_mfma_f32_16x16x32_bf16 v[140:143], a[248:251], a[184:187], v[140:143]
    buffer_load_dwordx4 v214, s[20:23], s63 offen offset:3072 lds
    v_max_f32 v252, v252, v207
    v_mfma_f32_16x16x32_bf16 v[140:143], a[252:255], a[188:191], v[140:143]
    v_cmp_nge_f32 vcc, s33, v252
    s_nop 7
    v_max3_f32 v241, v241, v140, v141
    v_max3_f32 v241, v241, v142, v143
    s_nop 1
    v_permlane32_swap_b32 v240, v241
    v_max_f32 v240, v240, v241
    v_mov_b32 v242, v240
    s_nop 1
    v_permlane16_swap_b32 v240, v242
    v_max_f32 v240, v240, v242
    v_mul_f32 v240, s32, v240
    ds_write_b32 v215, v240 offset:1024
    s_cbranch_vccnz L_notify0
L_notified0:
    s_waitcnt lgkmcnt(0)
    s_barrier
    ds_read_b128 v[244:247], v216 offset:1024
    ds_read_b128 v[248:251], v216 offset:1280
    ds_read_b32 v218, v217
    s_mov_b32 m0, s41
    s_nop 0
    buffer_load_dwordx4 v214, s[20:23], s64 offen offset:0 lds
    s_waitcnt lgkmcnt(2)
    v_max3_f32 v244, v244, v245, v246
    s_waitcnt lgkmcnt(1)
    v_max3_f32 v248, v248, v249, v250
    v_max_f32 v196, v244, v247
    v_max_f32 v197, v248, v251
    s_waitcnt lgkmcnt(0)
    v_cmp_ne_u32 vcc, 0, v218
    v_fma_f32 v228, v128, s32, -v196
    v_fma_f32 v229, v129, s32, -v196
    v_exp_f32 v228, v228
    v_fma_f32 v230, v130, s32, -v196
    v_exp_f32 v229, v229
    v_fma_f32 v231, v131, s32, -v196
    buffer_load_dwordx4 v214, s[20:23], s65 offen offset:1024 lds
    v_exp_f32 v230, v230
    v_add_f32 v208, v228, v229
    v_cvt_pk_bf16_f32 v160, v228, v229
    v_fma_f32 v232, v132, s32, -v196
    v_exp_f32 v231, v231
    v_add_f32 v208, v208, v230
    v_fma_f32 v233, v133, s32, -v196
    v_exp_f32 v232, v232
    v_add_f32 v208, v208, v231
    v_cvt_pk_bf16_f32 v161, v230, v231
    v_fma_f32 v234, v134, s32, -v196
    buffer_load_dwordx4 v214, s[20:23], s66 offen offset:2048 lds
    v_exp_f32 v233, v233
    v_add_f32 v208, v208, v232
    v_fma_f32 v235, v135, s32, -v196
    v_exp_f32 v234, v234
    v_add_f32 v208, v208, v233
    v_cvt_pk_bf16_f32 v162, v232, v233
    v_fma_f32 v236, v136, s32, -v197
    v_exp_f32 v235, v235
    v_add_f32 v208, v208, v234
    v_fma_f32 v237, v137, s32, -v197
    v_exp_f32 v236, v236
    s_mov_b32 m0, s41
    s_nop 0
    buffer_load_dwordx4 v214, s[20:23], s67 offen offset:3072 lds
    v_add_f32 v208, v208, v235
    v_cvt_pk_bf16_f32 v163, v234, v235
    v_fma_f32 v238, v138, s32, -v197
    v_exp_f32 v237, v237
    v_fma_f32 v239, v139, s32, -v197
    v_exp_f32 v238, v238
    v_add_f32 v209, v236, v237
    v_cvt_pk_bf16_f32 v164, v236, v237
    v_fma_f32 v228, v140, s32, -v197
    v_exp_f32 v239, v239
    s_waitcnt vmcnt(16)
    ds_read_b128 a[192:195], v210 offset:0
    ds_read_b128 a[196:199], v210 offset:64
    ds_read_b128 a[200:203], v210 offset:128
    ds_read_b128 a[204:207], v210 offset:192
    ds_read_b128 a[208:211], v210 offset:256
    ds_read_b128 a[212:215], v210 offset:320
    ds_read_b128 a[216:219], v210 offset:384
    ds_read_b128 a[220:223], v210 offset:448
    v_add_f32 v209, v209, v238
    v_fma_f32 v229, v141, s32, -v197
    v_exp_f32 v228, v228
    v_add_f32 v209, v209, v239
    v_cvt_pk_bf16_f32 v165, v238, v239
    v_fma_f32 v230, v142, s32, -v197
    v_exp_f32 v229, v229
    v_add_f32 v209, v209, v228
    v_fma_f32 v231, v143, s32, -v197
    v_exp_f32 v230, v230
    v_add_f32 v209, v209, v229
    v_cvt_pk_bf16_f32 v166, v228, v229
    v_exp_f32 v231, v231
    v_add_f32 v209, v209, v230
    v_add_f32 v209, v209, v231
    v_cvt_pk_bf16_f32 v167, v230, v231
    s_waitcnt lgkmcnt(0)
    s_cbranch_vccnz L_slow
.p2align 6
L_loop:
    v_mfma_f32_16x16x32_bf16 v[96:99], a[192:195], a[0:3], 0
    ds_write_b128 v212, v[144:147] offset:0
    v_mfma_f32_16x16x32_bf16 v[96:99], a[196:199], a[4:7], v[96:99]
    v_add_f32 v198, v198, v204
    v_add_f32 v199, v199, v205
    v_mfma_f32_16x16x32_bf16 v[96:99], a[200:203], a[8:11], v[96:99]
    v_add_f32 v200, v200, v206
    v_add_f32 v201, v201, v207
    v_mfma_f32_16x16x32_bf16 v[96:99], a[204:207], a[12:15], v[96:99]
    s_waitcnt vmcnt(8)
    ds_read_b128 a[224:227], v210 offset:8448
    v_add_f32 v202, v202, v208
    v_mfma_f32_16x16x32_bf16 v[96:99], a[208:211], a[16:19], v[96:99]
    ds_read_b128 a[228:231], v210 offset:8512
    v_add_f32 v203, v203, v209
    v_mfma_f32_16x16x32_bf16 v[96:99], a[212:215], a[20:23], v[96:99]
    ds_write_b128 v212, v[148:151] offset:1024
    v_mfma_f32_16x16x32_bf16 v[96:99], a[216:219], a[24:27], v[96:99]
    ds_read_b128 a[232:235], v210 offset:8576
    v_mfma_f32_16x16x32_bf16 v[96:99], a[220:223], a[28:31], v[96:99]
    ds_read_b128 a[236:239], v210 offset:8640
    v_mfma_f32_16x16x32_bf16 v[104:107], a[192:195], a[32:35], 0
    ds_read_b128 a[240:243], v210 offset:8704
    v_mfma_f32_16x16x32_bf16 v[104:107], a[196:199], a[36:39], v[104:107]
    ds_read_b128 a[244:247], v210 offset:8768
    v_mfma_f32_16x16x32_bf16 v[104:107], a[200:203], a[40:43], v[104:107]
    ds_write_b128 v212, v[152:155] offset:2048
    v_mfma_f32_16x16x32_bf16 v[104:107], a[204:207], a[44:47], v[104:107]
    ds_read_b128 a[248:251], v210 offset:8832
    v_fma_f32 v228, v96, s32, -v192
    v_fma_f32 v229, v97, s32, -v192
    v_mfma_f32_16x16x32_bf16 v[104:107], a[208:211], a[48:51], v[104:107]
    ds_read_b128 a[252:255], v210 offset:8896
    v_exp_f32 v228, v228
    v_mfma_f32_16x16x32_bf16 v[104:107], a[212:215], a[52:55], v[104:107]
    v_exp_f32 v229, v229
    v_fma_f32 v230, v98, s32, -v192
    v_mfma_f32_16x16x32_bf16 v[104:107], a[216:219], a[56:59], v[104:107]
    v_exp_f32 v230, v230
    v_fma_f32 v231, v99, s32, -v192
    v_mfma_f32_16x16x32_bf16 v[104:107], a[220:223], a[60:63], v[104:107]
    ds_write_b128 v212, v[156:159] offset:3072
    v_mfma_f32_16x16x32_bf16 v[112:115], a[192:195], a[64:67], 0
    v_exp_f32 v231, v231
    v_add_f32 v204, v228, v229
    v_mfma_f32_16x16x32_bf16 v[112:115], a[196:199], a[68:71], v[112:115]
    v_cvt_pk_bf16_f32 v144, v228, v229
    v_add_f32 v204, v204, v230
    v_cvt_pk_bf16_f32 v145, v230, v231
    v_mfma_f32_16x16x32_bf16 v[112:115], a[200:203], a[72:75], v[112:115]
    v_add_f32 v204, v204, v231
    v_mfma_f32_16x16x32_bf16 v[112:115], a[204:207], a[76:79], v[112:115]
    v_fma_f32 v232, v104, s32, -v193
    v_fma_f32 v233, v105, s32, -v193
    v_fma_f32 v234, v106, s32, -v193
    v_mfma_f32_16x16x32_bf16 v[112:115], a[208:211], a[80:83], v[112:115]
    ds_write_b128 v212, v[160:163] offset:4096
    v_mfma_f32_16x16x32_bf16 v[112:115], a[212:215], a[84:87], v[112:115]
    v_exp_f32 v232, v232
    v_fma_f32 v235, v107, s32, -v193
    v_mfma_f32_16x16x32_bf16 v[112:115], a[216:219], a[88:91], v[112:115]
    v_exp_f32 v233, v233
    v_mfma_f32_16x16x32_bf16 v[112:115], a[220:223], a[92:95], v[112:115]
    v_exp_f32 v234, v234
    v_add_f32 v205, v232, v233
    v_mfma_f32_16x16x32_bf16 v[120:123], a[192:195], a[96:99], 0
    v_exp_f32 v235, v235
    v_cvt_pk_bf16_f32 v148, v232, v233
    v_mfma_f32_16x16x32_bf16 v[120:123], a[196:199], a[100:103], v[120:123]
    ds_write_b128 v212, v[164:167] offset:5120
    v_mfma_f32_16x16x32_bf16 v[120:123], a[200:203], a[104:107], v[120:123]
    v_add_f32 v205, v205, v234
    v_cvt_pk_bf16_f32 v149, v234, v235
    v_mfma_f32_16x16x32_bf16 v[120:123], a[204:207], a[108:111], v[120:123]
    v_fma_f32 v236, v112, s32, -v194
    v_fma_f32 v237, v113, s32, -v194
    v_add_f32 v205, v205, v235
    v_mfma_f32_16x16x32_bf16 v[120:123], a[208:211], a[112:115], v[120:123]
    v_exp_f32 v236, v236
    v_mfma_f32_16x16x32_bf16 v[120:123], a[212:215], a[116:119], v[120:123]
    s_mov_b32 m0, s42
    v_exp_f32 v237, v237
    v_mfma_f32_16x16x32_bf16 v[120:123], a[216:219], a[120:123], v[120:123]
    buffer_load_dwordx4 v214, s[20:23], s68 offen offset:0 lds
    v_mfma_f32_16x16x32_bf16 v[120:123], a[220:223], a[124:127], v[120:123]
    v_fma_f32 v238, v114, s32, -v194
    v_fma_f32 v239, v115, s32, -v194
    v_mfma_f32_16x16x32_bf16 v[128:131], a[192:195], a[128:131], 0
    v_exp_f32 v238, v238
    v_mfma_f32_16x16x32_bf16 v[128:131], a[196:199], a[132:135], v[128:131]
    v_exp_f32 v239, v239
    v_mfma_f32_16x16x32_bf16 v[128:131], a[200:203], a[136:139], v[128:131]
    buffer_load_dwordx4 v214, s[20:23], s69 offen offset:1024 lds
    v_mfma_f32_16x16x32_bf16 v[128:131], a[204:207], a[140:143], v[128:131]
    v_add_f32 v206, v236, v237
    v_cvt_pk_bf16_f32 v152, v236, v237
    v_mfma_f32_16x16x32_bf16 v[128:131], a[208:211], a[144:147], v[128:131]
    v_fma_f32 v228, v120, s32, -v195
    v_add_f32 v206, v206, v238
    v_mfma_f32_16x16x32_bf16 v[128:131], a[212:215], a[148:151], v[128:131]
    v_exp_f32 v228, v228
    v_mfma_f32_16x16x32_bf16 v[128:131], a[216:219], a[152:155], v[128:131]
    buffer_load_dwordx4 v214, s[20:23], s70 offen offset:2048 lds
    v_mfma_f32_16x16x32_bf16 v[128:131], a[220:223], a[156:159], v[128:131]
    v_fma_f32 v229, v121, s32, -v195
    v_add_f32 v206, v206, v239
    v_mfma_f32_16x16x32_bf16 v[136:139], a[192:195], a[160:163], 0
    v_exp_f32 v229, v229
    v_mfma_f32_16x16x32_bf16 v[136:139], a[196:199], a[164:167], v[136:139]
    v_cvt_pk_bf16_f32 v153, v238, v239
    v_fma_f32 v230, v122, s32, -v195
    v_mfma_f32_16x16x32_bf16 v[136:139], a[200:203], a[168:171], v[136:139]
    buffer_load_dwordx4 v214, s[20:23], s71 offen offset:3072 lds
    v_mfma_f32_16x16x32_bf16 v[136:139], a[204:207], a[172:175], v[136:139]
    v_exp_f32 v230, v230
    v_mfma_f32_16x16x32_bf16 v[136:139], a[208:211], a[176:179], v[136:139]
    v_fma_f32 v231, v123, s32, -v195
    v_add_f32 v207, v228, v229
    v_mfma_f32_16x16x32_bf16 v[136:139], a[212:215], a[180:183], v[136:139]
    s_mov_b32 m0, s43
    v_exp_f32 v231, v231
    v_mfma_f32_16x16x32_bf16 v[136:139], a[216:219], a[184:187], v[136:139]
    buffer_load_dwordx4 v214, s[20:23], s72 offen offset:0 lds
    v_mfma_f32_16x16x32_bf16 v[136:139], a[220:223], a[188:191], v[136:139]
    s_waitcnt lgkmcnt(3)
    v_cvt_pk_bf16_f32 v156, v228, v229
    v_fma_f32 v232, v128, s32, -v196
    v_mfma_f32_16x16x32_bf16 v[100:103], a[224:227], a[0:3], 0
    v_exp_f32 v232, v232
    v_mfma_f32_16x16x32_bf16 v[100:103], a[228:231], a[4:7], v[100:103]
    v_add_f32 v207, v207, v230
    v_fma_f32 v233, v129, s32, -v196
    v_mfma_f32_16x16x32_bf16 v[100:103], a[232:235], a[8:11], v[100:103]
    buffer_load_dwordx4 v214, s[20:23], s73 offen offset:1024 lds
    v_mfma_f32_16x16x32_bf16 v[100:103], a[236:239], a[12:15], v[100:103]
    v_exp_f32 v233, v233
    v_mfma_f32_16x16x32_bf16 v[100:103], a[240:243], a[16:19], v[100:103]
    s_waitcnt vmcnt(12)
    ds_read_b64_tr_b16 a[192:193], v224 offset:0
    v_add_f32 v207, v207, v231
    v_mfma_f32_16x16x32_bf16 v[100:103], a[244:247], a[20:23], v[100:103]
    ds_read_b64_tr_b16 a[200:201], v225 offset:0
    v_cvt_pk_bf16_f32 v157, v230, v231
    v_mfma_f32_16x16x32_bf16 v[100:103], a[248:251], a[24:27], v[100:103]
    buffer_load_dwordx4 v214, s[20:23], s74 offen offset:2048 lds
    v_mfma_f32_16x16x32_bf16 v[100:103], a[252:255], a[28:31], v[100:103]
    ds_read_b64_tr_b16 a[208:209], v226 offset:0
    v_fma_f32 v234, v130, s32, -v196
    v_mfma_f32_16x16x32_bf16 v[108:111], a[224:227], a[32:35], 0
    ds_read_b64_tr_b16 a[216:217], v227 offset:0
    v_fma_f32 v235, v131, s32, -v196
    v_mfma_f32_16x16x32_bf16 v[108:111], a[228:231], a[36:39], v[108:111]
    v_exp_f32 v234, v234
    v_mfma_f32_16x16x32_bf16 v[108:111], a[232:235], a[40:43], v[108:111]
    buffer_load_dwordx4 v214, s[20:23], s75 offen offset:3072 lds
    v_mfma_f32_16x16x32_bf16 v[108:111], a[236:239], a[44:47], v[108:111]
    v_add_u32 v214, s7, v214
    v_add_f32 v208, v232, v233
    v_mfma_f32_16x16x32_bf16 v[108:111], a[240:243], a[48:51], v[108:111]
    s_waitcnt vmcnt(12)
    v_exp_f32 v235, v235
    v_mfma_f32_16x16x32_bf16 v[108:111], a[244:247], a[52:55], v[108:111]
    s_mov_b32 m0, s36
    ds_read_b64_tr_b16 a[194:195], v224 offset:2048
    v_cvt_pk_bf16_f32 v160, v232, v233
    v_mfma_f32_16x16x32_bf16 v[108:111], a[248:251], a[56:59], v[108:111]
    buffer_load_dwordx4 v213, s[16:19], s44 offen offset:0 lds
    v_mfma_f32_16x16x32_bf16 v[108:111], a[252:255], a[60:63], v[108:111]
    ds_read_b64_tr_b16 a[202:203], v225 offset:2048
    v_fma_f32 v236, v136, s32, -v197
    v_mfma_f32_16x16x32_bf16 v[116:119], a[224:227], a[64:67], 0
    ds_read_b64_tr_b16 a[210:211], v226 offset:2048
    v_add_f32 v208, v208, v234
    v_mfma_f32_16x16x32_bf16 v[116:119], a[228:231], a[68:71], v[116:119]
    ds_read_b64_tr_b16 a[218:219], v227 offset:2048
    v_fma_f32 v237, v137, s32, -v197
    v_mfma_f32_16x16x32_bf16 v[116:119], a[232:235], a[72:75], v[116:119]
    v_exp_f32 v236, v236
    v_mfma_f32_16x16x32_bf16 v[116:119], a[236:239], a[76:79], v[116:119]
    buffer_load_dwordx4 v213, s[16:19], s45 offen offset:1056 lds
    v_mfma_f32_16x16x32_bf16 v[116:119], a[240:243], a[80:83], v[116:119]
    v_exp_f32 v237, v237
    v_mfma_f32_16x16x32_bf16 v[116:119], a[244:247], a[84:87], v[116:119]
    v_add_f32 v208, v208, v235
    v_cvt_pk_bf16_f32 v161, v234, v235
    v_mfma_f32_16x16x32_bf16 v[116:119], a[248:251], a[88:91], v[116:119]
    v_fma_f32 v238, v138, s32, -v197
    v_fma_f32 v239, v139, s32, -v197
    v_mfma_f32_16x16x32_bf16 v[116:119], a[252:255], a[92:95], v[116:119]
    s_waitcnt vmcnt(12)
    ds_read_b64_tr_b16 a[196:197], v224 offset:4096
    v_add_f32 v209, v236, v237
    v_mfma_f32_16x16x32_bf16 v[124:127], a[224:227], a[96:99], 0
    buffer_load_dwordx4 v213, s[16:19], s46 offen offset:2112 lds
    v_mfma_f32_16x16x32_bf16 v[124:127], a[228:231], a[100:103], v[124:127]
    ds_read_b64_tr_b16 a[204:205], v225 offset:4096
    v_cvt_pk_bf16_f32 v164, v236, v237
    v_mfma_f32_16x16x32_bf16 v[124:127], a[232:235], a[104:107], v[124:127]
    s_waitcnt lgkmcnt(10)
    s_barrier
    v_mfma_f32_16x16x32_bf16 v[124:127], a[236:239], a[108:111], v[124:127]
    ds_read_b64_tr_b16 a[212:213], v226 offset:4096
    v_fma_f32 v228, v100, s32, -v192
    v_mfma_f32_16x16x32_bf16 v[124:127], a[240:243], a[112:115], v[124:127]
    ds_read_b64_tr_b16 a[220:221], v227 offset:4096
    v_fma_f32 v229, v101, s32, -v192
    v_mfma_f32_16x16x32_bf16 v[124:127], a[244:247], a[116:119], v[124:127]
    buffer_load_dwordx4 v213, s[16:19], s47 offen offset:3168 lds
    v_mfma_f32_16x16x32_bf16 v[124:127], a[248:251], a[120:123], v[124:127]
    v_exp_f32 v238, v238
    v_mfma_f32_16x16x32_bf16 v[124:127], a[252:255], a[124:127], v[124:127]
    v_exp_f32 v239, v239
    v_mfma_f32_16x16x32_bf16 v[132:135], a[224:227], a[128:131], 0
    ds_read_b128 v[168:171], v211 offset:0
    v_add_f32 v209, v209, v238
    v_mfma_f32_16x16x32_bf16 v[132:135], a[228:231], a[132:135], v[132:135]
    s_mov_b32 m0, s37
    ds_read_b128 v[172:175], v211 offset:6144
    v_add_f32 v209, v209, v239
    v_mfma_f32_16x16x32_bf16 v[132:135], a[232:235], a[136:139], v[132:135]
    buffer_load_dwordx4 v213, s[16:19], s48 offen offset:0 lds
    v_mfma_f32_16x16x32_bf16 v[132:135], a[236:239], a[140:143], v[132:135]
    s_waitcnt vmcnt(13)
    ds_read_b64_tr_b16 a[198:199], v224 offset:6144
    v_cvt_pk_bf16_f32 v165, v238, v239
    v_mfma_f32_16x16x32_bf16 v[132:135], a[240:243], a[144:147], v[132:135]
    ds_read_b64_tr_b16 a[206:207], v225 offset:6144
    v_fma_f32 v230, v102, s32, -v192
    v_mfma_f32_16x16x32_bf16 v[132:135], a[244:247], a[148:151], v[132:135]
    ds_read_b64_tr_b16 a[214:215], v226 offset:6144
    v_fma_f32 v231, v103, s32, -v192
    v_mfma_f32_16x16x32_bf16 v[132:135], a[248:251], a[152:155], v[132:135]
    ds_read_b64_tr_b16 a[222:223], v227 offset:6144
    v_fma_f32 v232, v108, s32, -v193
    v_mfma_f32_16x16x32_bf16 v[132:135], a[252:255], a[156:159], v[132:135]
    buffer_load_dwordx4 v213, s[16:19], s49 offen offset:1056 lds
    v_mfma_f32_16x16x32_bf16 v[140:143], a[224:227], a[160:163], 0
    ds_read_b128 v[176:179], v211 offset:1024
    v_fma_f32 v233, v109, s32, -v193
    v_mfma_f32_16x16x32_bf16 v[140:143], a[228:231], a[164:167], v[140:143]
    ds_read_b128 v[180:183], v211 offset:7168
    v_fma_f32 v234, v110, s32, -v193
    v_mfma_f32_16x16x32_bf16 v[140:143], a[232:235], a[168:171], v[140:143]
    v_exp_f32 v228, v228
    v_mfma_f32_16x16x32_bf16 v[140:143], a[236:239], a[172:175], v[140:143]
    v_exp_f32 v229, v229
    v_mfma_f32_16x16x32_bf16 v[140:143], a[240:243], a[176:179], v[140:143]
    buffer_load_dwordx4 v213, s[16:19], s50 offen offset:2112 lds
    v_mfma_f32_16x16x32_bf16 v[140:143], a[244:247], a[180:183], v[140:143]
    v_exp_f32 v230, v230
    v_mfma_f32_16x16x32_bf16 v[140:143], a[248:251], a[184:187], v[140:143]
    v_exp_f32 v231, v231
    v_mfma_f32_16x16x32_bf16 v[140:143], a[252:255], a[188:191], v[140:143]
    s_waitcnt lgkmcnt(2)
    v_exp_f32 v232, v232
    v_mfma_f32_16x16x32_bf16 v[0:3], a[192:195], v[168:171], v[0:3]
    ds_read_b128 v[184:187], v211 offset:2048
    v_add_f32 v204, v204, v228
    v_mfma_f32_16x16x32_bf16 v[0:3], a[196:199], v[172:175], v[0:3]
    buffer_load_dwordx4 v213, s[16:19], s51 offen offset:3168 lds
    v_mfma_f32_16x16x32_bf16 v[4:7], a[200:203], v[168:171], v[4:7]
    ds_read_b128 v[188:191], v211 offset:8192
    v_add_f32 v204, v204, v229
    v_mfma_f32_16x16x32_bf16 v[4:7], a[204:207], v[172:175], v[4:7]
    v_exp_f32 v233, v233
    v_mfma_f32_16x16x32_bf16 v[8:11], a[208:211], v[168:171], v[8:11]
    s_waitcnt vmcnt(14)
    ds_read_b64_tr_b16 a[224:225], v224 offset:8192
    v_cvt_pk_bf16_f32 v146, v228, v229
    v_mfma_f32_16x16x32_bf16 v[8:11], a[212:215], v[172:175], v[8:11]
    ds_read_b64_tr_b16 a[232:233], v225 offset:8192
    v_add_f32 v204, v204, v230
    v_mfma_f32_16x16x32_bf16 v[12:15], a[216:219], v[168:171], v[12:15]
    ds_read_b64_tr_b16 a[240:241], v226 offset:8192
    v_add_f32 v204, v204, v231
    v_mfma_f32_16x16x32_bf16 v[12:15], a[220:223], v[172:175], v[12:15]
    s_waitcnt lgkmcnt(5)
    ds_read_b64_tr_b16 a[248:249], v227 offset:8192
    v_cvt_pk_bf16_f32 v147, v230, v231
    v_mfma_f32_16x16x32_bf16 v[16:19], a[192:195], v[176:179], v[16:19]
    ds_read_b128 v[168:171], v211 offset:3072
    v_add_f32 v205, v205, v232
    v_mfma_f32_16x16x32_bf16 v[16:19], a[196:199], v[180:183], v[16:19]
    ds_read_b128 v[172:175], v211 offset:9216
    v_fma_f32 v235, v111, s32, -v193
    v_mfma_f32_16x16x32_bf16 v[20:23], a[200:203], v[176:179], v[20:23]
    v_exp_f32 v234, v234
    v_mfma_f32_16x16x32_bf16 v[20:23], a[204:207], v[180:183], v[20:23]
    v_exp_f32 v235, v235
    v_mfma_f32_16x16x32_bf16 v[24:27], a[208:211], v[176:179], v[24:27]
    v_add_f32 v205, v205, v233
    v_cvt_pk_bf16_f32 v150, v232, v233
    v_mfma_f32_16x16x32_bf16 v[24:27], a[212:215], v[180:183], v[24:27]
    s_waitcnt vmcnt(12)
    ds_read_b64_tr_b16 a[226:227], v224 offset:10240
    v_fma_f32 v236, v116, s32, -v194
    v_mfma_f32_16x16x32_bf16 v[28:31], a[216:219], v[176:179], v[28:31]
    s_waitcnt lgkmcnt(7)
    ds_read_b64_tr_b16 a[234:235], v225 offset:10240
    v_add_f32 v205, v205, v234
    v_mfma_f32_16x16x32_bf16 v[28:31], a[220:223], v[180:183], v[28:31]
    s_mov_b32 m0, s38
    ds_read_b64_tr_b16 a[242:243], v226 offset:10240
    v_fma_f32 v237, v117, s32, -v194
    v_mfma_f32_16x16x32_bf16 v[32:35], a[192:195], v[184:187], v[32:35]
    buffer_load_dwordx4 v213, s[16:19], s52 offen offset:0 lds
    v_mfma_f32_16x16x32_bf16 v[32:35], a[196:199], v[188:191], v[32:35]
    ds_read_b128 v[176:179], v211 offset:4096
    v_add_f32 v205, v205, v235
    v_mfma_f32_16x16x32_bf16 v[36:39], a[200:203], v[184:187], v[36:39]
    ds_read_b128 v[180:183], v211 offset:10240
    v_cvt_pk_bf16_f32 v151, v234, v235
    v_mfma_f32_16x16x32_bf16 v[36:39], a[204:207], v[188:191], v[36:39]
    ds_read_b64_tr_b16 a[250:251], v227 offset:10240
    v_fma_f32 v238, v118, s32, -v194
    v_mfma_f32_16x16x32_bf16 v[40:43], a[208:211], v[184:187], v[40:43]
    v_exp_f32 v236, v236
    v_mfma_f32_16x16x32_bf16 v[40:43], a[212:215], v[188:191], v[40:43]
    buffer_load_dwordx4 v213, s[16:19], s53 offen offset:1056 lds
    v_mfma_f32_16x16x32_bf16 v[44:47], a[216:219], v[184:187], v[44:47]
    v_exp_f32 v237, v237
    v_mfma_f32_16x16x32_bf16 v[44:47], a[220:223], v[188:191], v[44:47]
    s_waitcnt vmcnt(12) lgkmcnt(6)
    ds_read_b64_tr_b16 a[228:229], v224 offset:12288
    v_add_f32 v206, v206, v236
    v_mfma_f32_16x16x32_bf16 v[48:51], a[192:195], v[168:171], v[48:51]
    ds_read_b128 v[184:187], v211 offset:5120
    v_fma_f32 v239, v119, s32, -v194
    v_mfma_f32_16x16x32_bf16 v[48:51], a[196:199], v[172:175], v[48:51]
    ds_read_b128 v[188:191], v211 offset:11264
    v_add_f32 v206, v206, v237
    v_mfma_f32_16x16x32_bf16 v[52:55], a[200:203], v[168:171], v[52:55]
    buffer_load_dwordx4 v213, s[16:19], s54 offen offset:2112 lds
    v_mfma_f32_16x16x32_bf16 v[52:55], a[204:207], v[172:175], v[52:55]
    ds_read_b64_tr_b16 a[236:237], v225 offset:12288
    v_cvt_pk_bf16_f32 v154, v236, v237
    v_mfma_f32_16x16x32_bf16 v[56:59], a[208:211], v[168:171], v[56:59]
    ds_read_b64_tr_b16 a[244:245], v226 offset:12288
    v_fma_f32 v228, v124, s32, -v195
    v_mfma_f32_16x16x32_bf16 v[56:59], a[212:215], v[172:175], v[56:59]
    ds_read_b64_tr_b16 a[252:253], v227 offset:12288
    v_fma_f32 v229, v125, s32, -v195
    v_mfma_f32_16x16x32_bf16 v[60:63], a[216:219], v[168:171], v[60:63]
    v_exp_f32 v238, v238
    v_mfma_f32_16x16x32_bf16 v[60:63], a[220:223], v[172:175], v[60:63]
    s_waitcnt lgkmcnt(7)
    buffer_load_dwordx4 v213, s[16:19], s55 offen offset:3168 lds
    v_mfma_f32_16x16x32_bf16 v[64:67], a[192:195], v[176:179], v[64:67]
    ds_read_b128 v[168:171], v211 offset:12288
    v_add_f32 v206, v206, v238
    v_mfma_f32_16x16x32_bf16 v[64:67], a[196:199], v[180:183], v[64:67]
    ds_read_b128 v[172:175], v211 offset:18432
    v_fma_f32 v230, v126, s32, -v195
    v_mfma_f32_16x16x32_bf16 v[68:71], a[200:203], v[176:179], v[68:71]
    s_waitcnt vmcnt(12)
    ds_read_b64_tr_b16 a[230:231], v224 offset:14336
    v_fma_f32 v231, v127, s32, -v195
    v_mfma_f32_16x16x32_bf16 v[68:71], a[204:207], v[180:183], v[68:71]
    s_mov_b32 m0, s39
    ds_read_b64_tr_b16 a[238:239], v225 offset:14336
    v_fma_f32 v232, v132, s32, -v196
    v_mfma_f32_16x16x32_bf16 v[72:75], a[208:211], v[176:179], v[72:75]
    buffer_load_dwordx4 v213, s[16:19], s56 offen offset:0 lds
    v_mfma_f32_16x16x32_bf16 v[72:75], a[212:215], v[180:183], v[72:75]
    ds_read_b64_tr_b16 a[246:247], v226 offset:14336
    v_fma_f32 v233, v133, s32, -v196
    v_mfma_f32_16x16x32_bf16 v[76:79], a[216:219], v[176:179], v[76:79]
    ds_read_b64_tr_b16 a[254:255], v227 offset:14336
    v_fma_f32 v234, v134, s32, -v196
    v_mfma_f32_16x16x32_bf16 v[76:79], a[220:223], v[180:183], v[76:79]
    s_waitcnt lgkmcnt(9)
    v_exp_f32 v239, v239
    v_mfma_f32_16x16x32_bf16 v[80:83], a[192:195], v[184:187], v[80:83]
    ds_read_b128 v[176:179], v211 offset:13312
    v_add_f32 v206, v206, v239
    v_mfma_f32_16x16x32_bf16 v[80:83], a[196:199], v[188:191], v[80:83]
    buffer_load_dwordx4 v213, s[16:19], s57 offen offset:1056 lds
    v_mfma_f32_16x16x32_bf16 v[84:87], a[200:203], v[184:187], v[84:87]
    ds_read_b128 v[180:183], v211 offset:19456
    v_max3_f32 v252, v204, v205, v206
    v_mfma_f32_16x16x32_bf16 v[84:87], a[204:207], v[188:191], v[84:87]
    v_exp_f32 v228, v228
    v_mfma_f32_16x16x32_bf16 v[88:91], a[208:211], v[184:187], v[88:91]
    v_exp_f32 v229, v229
    v_mfma_f32_16x16x32_bf16 v[88:91], a[212:215], v[188:191], v[88:91]
    v_exp_f32 v230, v230
    v_mfma_f32_16x16x32_bf16 v[92:95], a[216:219], v[184:187], v[92:95]
    buffer_load_dwordx4 v213, s[16:19], s58 offen offset:2112 lds
    v_mfma_f32_16x16x32_bf16 v[92:95], a[220:223], v[188:191], v[92:95]
    s_waitcnt lgkmcnt(2)
    v_exp_f32 v231, v231
    v_mfma_f32_16x16x32_bf16 v[0:3], a[224:227], v[168:171], v[0:3]
    ds_read_b128 v[184:187], v211 offset:14336
    v_cvt_pk_bf16_f32 v155, v238, v239
    v_mfma_f32_16x16x32_bf16 v[0:3], a[228:231], v[172:175], v[0:3]
    ds_read_b128 v[188:191], v211 offset:20480
    v_add_f32 v207, v207, v228
    v_mfma_f32_16x16x32_bf16 v[4:7], a[232:235], v[168:171], v[4:7]
    v_exp_f32 v232, v232
    v_mfma_f32_16x16x32_bf16 v[4:7], a[236:239], v[172:175], v[4:7]
    buffer_load_dwordx4 v213, s[16:19], s59 offen offset:3168 lds
    v_mfma_f32_16x16x32_bf16 v[8:11], a[240:243], v[168:171], v[8:11]
    v_add_u32 v213, s6, v213
    v_add_f32 v207, v207, v229
    v_mfma_f32_16x16x32_bf16 v[8:11], a[244:247], v[172:175], v[8:11]
    s_add_u32 s31, s31, 1
    v_exp_f32 v233, v233
    v_mfma_f32_16x16x32_bf16 v[12:15], a[248:251], v[168:171], v[12:15]
    v_exp_f32 v234, v234
    v_mfma_f32_16x16x32_bf16 v[12:15], a[252:255], v[172:175], v[12:15]
    s_waitcnt lgkmcnt(2)
    v_cvt_pk_bf16_f32 v158, v228, v229
    v_add_f32 v207, v207, v230
    v_mfma_f32_16x16x32_bf16 v[16:19], a[224:227], v[176:179], v[16:19]
    ds_read_b128 v[168:171], v211 offset:15360
    v_add_f32 v207, v207, v231
    v_mfma_f32_16x16x32_bf16 v[16:19], a[228:231], v[180:183], v[16:19]
    ds_read_b128 v[172:175], v211 offset:21504
    v_cvt_pk_bf16_f32 v159, v230, v231
    v_mfma_f32_16x16x32_bf16 v[20:23], a[232:235], v[176:179], v[20:23]
    v_add_f32 v208, v208, v232
    v_fma_f32 v235, v135, s32, -v196
    v_mfma_f32_16x16x32_bf16 v[20:23], a[236:239], v[180:183], v[20:23]
    v_exp_f32 v235, v235
    v_mfma_f32_16x16x32_bf16 v[24:27], a[240:243], v[176:179], v[24:27]
    s_cmp_lt_u32 s31, 6
    v_add_f32 v208, v208, v233
    v_cvt_pk_bf16_f32 v162, v232, v233
    v_mfma_f32_16x16x32_bf16 v[24:27], a[244:247], v[180:183], v[24:27]
    s_mov_b32 m0, s40
    v_fma_f32 v236, v140, s32, -v197
    v_add_f32 v208, v208, v234
    v_mfma_f32_16x16x32_bf16 v[28:31], a[248:251], v[176:179], v[28:31]
    buffer_load_dwordx4 v214, s[20:23], s60 offen offset:0 lds
    v_mfma_f32_16x16x32_bf16 v[28:31], a[252:255], v[180:183], v[28:31]
    s_waitcnt lgkmcnt(2)
    v_exp_f32 v236, v236
    v_mfma_f32_16x16x32_bf16 v[32:35], a[224:227], v[184:187], v[32:35]
    ds_read_b128 v[176:179], v211 offset:16384
    v_fma_f32 v237, v141, s32, -v197
    v_mfma_f32_16x16x32_bf16 v[32:35], a[228:231], v[188:191], v[32:35]
    ds_read_b128 v[180:183], v211 offset:22528
    v_add_f32 v208, v208, v235
    v_mfma_f32_16x16x32_bf16 v[36:39], a[232:235], v[184:187], v[36:39]
    buffer_load_dwordx4 v214, s[20:23], s61 offen offset:1024 lds
    v_mfma_f32_16x16x32_bf16 v[36:39], a[236:239], v[188:191], v[36:39]
    v_exp_f32 v237, v237
    v_mfma_f32_16x16x32_bf16 v[40:43], a[240:243], v[184:187], v[40:43]
    v_cvt_pk_bf16_f32 v163, v234, v235
    v_fma_f32 v238, v142, s32, -v197
    v_mfma_f32_16x16x32_bf16 v[40:43], a[244:247], v[188:191], v[40:43]
    v_exp_f32 v238, v238
    v_mfma_f32_16x16x32_bf16 v[44:47], a[248:251], v[184:187], v[44:47]
    buffer_load_dwordx4 v214, s[20:23], s62 offen offset:2048 lds
    v_mfma_f32_16x16x32_bf16 v[44:47], a[252:255], v[188:191], v[44:47]
    s_waitcnt lgkmcnt(2)
    v_add_f32 v209, v209, v236
    v_fma_f32 v239, v143, s32, -v197
    v_mfma_f32_16x16x32_bf16 v[48:51], a[224:227], v[168:171], v[48:51]
    ds_read_b128 v[184:187], v211 offset:17408
    v_add_f32 v209, v209, v237
    v_mfma_f32_16x16x32_bf16 v[48:51], a[228:231], v[172:175], v[48:51]
    ds_read_b128 v[188:191], v211 offset:23552
    v_max3_f32 v252, v252, v207, v208
    v_mfma_f32_16x16x32_bf16 v[52:55], a[232:235], v[168:171], v[52:55]
    buffer_load_dwordx4 v214, s[20:23], s63 offen offset:3072 lds
    v_mfma_f32_16x16x32_bf16 v[52:55], a[236:239], v[172:175], v[52:55]
    v_exp_f32 v239, v239
    v_mfma_f32_16x16x32_bf16 v[56:59], a[240:243], v[168:171], v[56:59]
    v_cvt_pk_bf16_f32 v166, v236, v237
    v_add_f32 v209, v209, v238
    v_mfma_f32_16x16x32_bf16 v[56:59], a[244:247], v[172:175], v[56:59]
    s_mov_b32 m0, s41
    v_add_f32 v209, v209, v239
    v_cvt_pk_bf16_f32 v167, v238, v239
    v_mfma_f32_16x16x32_bf16 v[60:63], a[248:251], v[168:171], v[60:63]
    buffer_load_dwordx4 v214, s[20:23], s64 offen offset:0 lds
    v_mfma_f32_16x16x32_bf16 v[60:63], a[252:255], v[172:175], v[60:63]
    s_waitcnt vmcnt(13) lgkmcnt(2)
    ds_read_b128 a[192:195], v210 offset:0
    v_max_f32 v252, v252, v209
    v_mfma_f32_16x16x32_bf16 v[64:67], a[224:227], v[176:179], v[64:67]
    ds_read_b128 a[196:199], v210 offset:64
    v_cmp_nge_f32 vcc, s33, v252
    v_mfma_f32_16x16x32_bf16 v[64:67], a[228:231], v[180:183], v[64:67]
    ds_read_b128 a[200:203], v210 offset:128
    v_mfma_f32_16x16x32_bf16 v[68:71], a[232:235], v[176:179], v[68:71]
    s_cbranch_vccnz L_notify
L_notified:
    buffer_load_dwordx4 v214, s[20:23], s65 offen offset:1024 lds
    v_mfma_f32_16x16x32_bf16 v[68:71], a[236:239], v[180:183], v[68:71]
    ds_read_b128 a[204:207], v210 offset:192
    v_mfma_f32_16x16x32_bf16 v[72:75], a[240:243], v[176:179], v[72:75]
    ds_read_b128 a[208:211], v210 offset:256
    v_mfma_f32_16x16x32_bf16 v[72:75], a[244:247], v[180:183], v[72:75]
    ds_read_b128 a[212:215], v210 offset:320
    v_mfma_f32_16x16x32_bf16 v[76:79], a[248:251], v[176:179], v[76:79]
    buffer_load_dwordx4 v214, s[20:23], s66 offen offset:2048 lds
    v_mfma_f32_16x16x32_bf16 v[76:79], a[252:255], v[180:183], v[76:79]
    s_waitcnt lgkmcnt(6)
    ds_read_b128 a[216:219], v210 offset:384
    v_mfma_f32_16x16x32_bf16 v[80:83], a[224:227], v[184:187], v[80:83]
    s_barrier
    v_mfma_f32_16x16x32_bf16 v[80:83], a[228:231], v[188:191], v[80:83]
    ds_read_b32 v218, v217
    v_mfma_f32_16x16x32_bf16 v[84:87], a[232:235], v[184:187], v[84:87]
    buffer_load_dwordx4 v214, s[20:23], s67 offen offset:3072 lds
    v_mfma_f32_16x16x32_bf16 v[84:87], a[236:239], v[188:191], v[84:87]
    ds_read_b128 a[220:223], v210 offset:448
    v_mfma_f32_16x16x32_bf16 v[88:91], a[240:243], v[184:187], v[88:91]
    v_mfma_f32_16x16x32_bf16 v[88:91], a[244:247], v[188:191], v[88:91]
    s_waitcnt lgkmcnt(1)
    v_cmp_ne_u32 vcc, 0, v218
    v_mfma_f32_16x16x32_bf16 v[92:95], a[248:251], v[184:187], v[92:95]
    v_mfma_f32_16x16x32_bf16 v[92:95], a[252:255], v[188:191], v[92:95]
    s_waitcnt lgkmcnt(0)
    s_cbranch_vccnz L_slow
L_slow_ret:
    s_cbranch_scc1 L_loop
    s_cmp_eq_u32 s31, 6
    s_cbranch_scc1 L_switch
    ds_read_b64_tr_b16 a[0:1], v253 offset:0
    ds_read_b64_tr_b16 a[2:3], v253 offset:2112
    ds_read_b64_tr_b16 a[16:17], v254 offset:0
    ds_read_b64_tr_b16 a[18:19], v254 offset:2112
    ds_read_b64_tr_b16 a[32:33], v255 offset:0
    ds_read_b64_tr_b16 a[34:35], v255 offset:2112
    ds_read_b64_tr_b16 a[48:49], v221 offset:0
    ds_read_b64_tr_b16 a[50:51], v221 offset:2112
    v_add_u32 v133, s79, v211
    v_add_u32 v134, s80, v211
    v_add_u32 v135, s81, v211
    v_add_f32 v240, v198, v204
    v_add_f32 v241, v199, v205
    v_add_f32 v242, v200, v206
    v_add_f32 v243, v201, v207
    v_add_f32 v244, v202, v208
    v_add_f32 v245, v203, v209
    s_waitcnt lgkmcnt(6)
    v_mfma_f32_16x16x32_bf16 v[0:3], a[0:3], v[144:147], v[0:3]
    ds_write_b128 v212, v[144:147] offset:0
    v_mfma_f32_16x16x32_bf16 v[16:19], a[0:3], v[148:151], v[16:19]
    ds_read_b64_tr_b16 a[4:5], v253 offset:4224
    ds_read_b64_tr_b16 a[6:7], v253 offset:6336
    v_permlane32_swap_b32 v240, v241
    v_permlane32_swap_b32 v242, v243
    v_permlane32_swap_b32 v244, v245
    v_mfma_f32_16x16x32_bf16 v[32:35], a[0:3], v[152:155], v[32:35]
    ds_read_b64_tr_b16 a[20:21], v254 offset:4224
    ds_read_b64_tr_b16 a[22:23], v254 offset:6336
    v_add_f32 v240, v240, v241
    v_add_f32 v242, v242, v243
    v_add_f32 v244, v244, v245
    v_mfma_f32_16x16x32_bf16 v[48:51], a[0:3], v[156:159], v[48:51]
    ds_write_b128 v212, v[148:151] offset:1024
    v_mfma_f32_16x16x32_bf16 v[64:67], a[0:3], v[160:163], v[64:67]
    ds_read_b64_tr_b16 a[36:37], v255 offset:4224
    ds_read_b64_tr_b16 a[38:39], v255 offset:6336
    v_mov_b32 v246, v240
    v_mov_b32 v247, v242
    v_mov_b32 v248, v244
    v_mfma_f32_16x16x32_bf16 v[80:83], a[0:3], v[164:167], v[80:83]
    ds_read_b64_tr_b16 a[52:53], v221 offset:4224
    ds_read_b64_tr_b16 a[54:55], v221 offset:6336
    v_permlane16_swap_b32 v240, v246
    v_permlane16_swap_b32 v242, v247
    v_permlane16_swap_b32 v244, v248
    s_waitcnt lgkmcnt(14)
    v_mfma_f32_16x16x32_bf16 v[4:7], a[16:19], v[144:147], v[4:7]
    ds_write_b128 v212, v[152:155] offset:2048
    v_mfma_f32_16x16x32_bf16 v[20:23], a[16:19], v[148:151], v[20:23]
    v_add_f32 v240, v240, v246
    v_add_f32 v242, v242, v247
    v_add_f32 v244, v244, v248
    v_mfma_f32_16x16x32_bf16 v[36:39], a[16:19], v[152:155], v[36:39]
    ds_write_b32 v215, v240 offset:2048
    v_mfma_f32_16x16x32_bf16 v[52:55], a[16:19], v[156:159], v[52:55]
    ds_write_b128 v212, v[156:159] offset:3072
    v_mfma_f32_16x16x32_bf16 v[68:71], a[16:19], v[160:163], v[68:71]
    ds_write_b32 v215, v242 offset:2560
    v_mfma_f32_16x16x32_bf16 v[84:87], a[16:19], v[164:167], v[84:87]
    ds_write_b32 v215, v244 offset:3072
    s_waitcnt lgkmcnt(15)
    v_mfma_f32_16x16x32_bf16 v[8:11], a[32:35], v[144:147], v[8:11]
    ds_write_b128 v212, v[160:163] offset:4096
    v_mfma_f32_16x16x32_bf16 v[24:27], a[32:35], v[148:151], v[24:27]
    s_waitcnt vmcnt(8)
    ds_read_b64_tr_b16 a[8:9], v253 offset:8448
    ds_read_b64_tr_b16 a[10:11], v253 offset:10560
    v_mfma_f32_16x16x32_bf16 v[40:43], a[32:35], v[152:155], v[40:43]
    ds_read_b64_tr_b16 a[12:13], v253 offset:12672
    ds_read_b64_tr_b16 a[14:15], v253 offset:14784
    v_mfma_f32_16x16x32_bf16 v[56:59], a[32:35], v[156:159], v[56:59]
    ds_write_b128 v212, v[164:167] offset:5120
    v_mfma_f32_16x16x32_bf16 v[72:75], a[32:35], v[160:163], v[72:75]
    ds_read_b64_tr_b16 a[24:25], v254 offset:8448
    ds_read_b64_tr_b16 a[26:27], v254 offset:10560
    v_and_b32 v228, 15, v220
    v_mfma_f32_16x16x32_bf16 v[88:91], a[32:35], v[164:167], v[88:91]
    ds_read_b64_tr_b16 a[28:29], v254 offset:12672
    ds_read_b64_tr_b16 a[30:31], v254 offset:14784
    v_lshrrev_b32 v229, 4, v220
    v_mfma_f32_16x16x32_bf16 v[12:15], a[48:51], v[144:147], v[12:15]
    ds_read_b64_tr_b16 a[40:41], v255 offset:8448
    ds_read_b64_tr_b16 a[42:43], v255 offset:10560
    v_mul_u32_u24 v228, 144, v228
    v_mfma_f32_16x16x32_bf16 v[28:31], a[48:51], v[148:151], v[28:31]
    s_waitcnt lgkmcnt(6)
    s_barrier
    ds_read_b128 a[68:71], v133 offset:0
    v_lshrrev_b32 v230, 3, v220
    v_mfma_f32_16x16x32_bf16 v[44:47], a[48:51], v[152:155], v[44:47]
    ds_read_b128 a[72:75], v134 offset:0
    ds_read_b128 a[76:79], v135 offset:0
    v_lshl_add_u32 v228, v229, 3, v228
    v_mfma_f32_16x16x32_bf16 v[60:63], a[48:51], v[156:159], v[60:63]
    ds_read_b128 v[96:99], v216 offset:2048
    ds_read_b64_tr_b16 a[44:45], v255 offset:12672
    v_mul_u32_u24 v230, 144, v230
    v_mfma_f32_16x16x32_bf16 v[76:79], a[48:51], v[160:163], v[76:79]
    ds_read_b64_tr_b16 a[46:47], v255 offset:14784
    ds_read_b64_tr_b16 a[56:57], v221 offset:8448
    v_add_u32 v213, s40, v228
    v_mfma_f32_16x16x32_bf16 v[92:95], a[48:51], v[164:167], v[92:95]
    s_waitcnt lgkmcnt(4)
    ds_read_b64_tr_b16 a[58:59], v221 offset:10560
    ds_read_b64_tr_b16 a[60:61], v221 offset:12672
    v_and_b32 v229, 7, v220
    v_mfma_f32_16x16x32_bf16 v[0:3], a[4:7], a[68:71], v[0:3]
    ds_read_b64_tr_b16 a[62:63], v221 offset:14784
    v_lshl_add_u32 v230, v229, 4, v230
    v_mfma_f32_16x16x32_bf16 v[0:3], a[8:11], a[72:75], v[0:3]
    s_mov_b32 s44, 0
    ds_read_b128 a[84:87], v133 offset:1024
    v_add_u32 v214, s40, v230
    v_mfma_f32_16x16x32_bf16 v[0:3], a[12:15], a[76:79], v[0:3]
    ds_read_b128 a[88:91], v134 offset:1024
    s_waitcnt lgkmcnt(8)
    v_add_f32 v96, v96, v97
    v_add_f32 v98, v98, v99
    v_mfma_f32_16x16x32_bf16 v[4:7], a[20:23], a[68:71], v[4:7]
    s_mov_b32 s45, 4096
    ds_read_b128 a[92:95], v135 offset:1024
    v_add_f32 v96, v96, v98
    v_mfma_f32_16x16x32_bf16 v[4:7], a[24:27], a[72:75], v[4:7]
    ds_read_b128 v[100:103], v216 offset:2304
    v_rcp_f32 v198, v96
    v_mfma_f32_16x16x32_bf16 v[4:7], a[28:31], a[76:79], v[4:7]
    s_mov_b32 s46, 8192
    v_mul_f32 v0, v0, v198
    v_mul_f32 v1, v1, v198
    v_mul_f32 v2, v2, v198
    v_mfma_f32_16x16x32_bf16 v[8:11], a[36:39], a[68:71], v[8:11]
    v_mul_f32 v3, v3, v198
    v_cvt_pk_bf16_f32 v0, v0, v1
    v_mfma_f32_16x16x32_bf16 v[8:11], a[40:43], a[72:75], v[8:11]
    s_mov_b32 s47, 12288
    v_cvt_pk_bf16_f32 v1, v2, v3
    s_waitcnt lgkmcnt(8)
    v_mfma_f32_16x16x32_bf16 v[8:11], a[44:47], a[76:79], v[8:11]
    s_waitcnt vmcnt(0)
    ds_write_b64 v213, v[0:1] offset:0
    v_mul_f32 v4, v4, v198
    v_mul_f32 v5, v5, v198
    v_mul_f32 v6, v6, v198
    v_mfma_f32_16x16x32_bf16 v[12:15], a[52:55], a[68:71], v[12:15]
    s_mov_b32 s48, 16384
    v_mul_f32 v7, v7, v198
    s_waitcnt lgkmcnt(1)
    v_add_f32 v100, v100, v101
    v_add_f32 v102, v102, v103
    v_mfma_f32_16x16x32_bf16 v[12:15], a[56:59], a[72:75], v[12:15]
    s_mov_b32 s49, 20480
    v_add_f32 v100, v100, v102
    v_cvt_pk_bf16_f32 v4, v4, v5
    v_mfma_f32_16x16x32_bf16 v[12:15], a[60:63], a[76:79], v[12:15]
    v_rcp_f32 v199, v100
    v_cvt_pk_bf16_f32 v5, v6, v7
    v_mfma_f32_16x16x32_bf16 v[16:19], a[4:7], a[84:87], v[16:19]
    ds_write_b64 v213, v[4:5] offset:32
    v_mul_f32 v8, v8, v198
    v_mul_f32 v9, v9, v198
    v_mul_f32 v10, v10, v198
    v_mfma_f32_16x16x32_bf16 v[16:19], a[8:11], a[88:91], v[16:19]
    s_mov_b32 s50, 24576
    ds_read_b128 a[100:103], v133 offset:2048
    v_mul_f32 v11, v11, v198
    v_cvt_pk_bf16_f32 v8, v8, v9
    v_mfma_f32_16x16x32_bf16 v[16:19], a[12:15], a[92:95], v[16:19]
    ds_read_b128 a[104:107], v134 offset:2048
    v_cvt_pk_bf16_f32 v9, v10, v11
    v_mul_f32 v12, v12, v198
    v_mfma_f32_16x16x32_bf16 v[20:23], a[20:23], a[84:87], v[20:23]
    s_mov_b32 s51, 28672
    ds_read_b128 a[108:111], v135 offset:2048
    ds_write_b64 v213, v[8:9] offset:64
    v_mul_f32 v13, v13, v198
    v_mul_f32 v14, v14, v198
    v_mfma_f32_16x16x32_bf16 v[20:23], a[24:27], a[88:91], v[20:23]
    ds_read_b128 v[104:107], v216 offset:2560
    v_mul_f32 v15, v15, v198
    v_cvt_pk_bf16_f32 v12, v12, v13
    v_mfma_f32_16x16x32_bf16 v[20:23], a[28:31], a[92:95], v[20:23]
    s_mov_b32 s52, 32768
    v_cvt_pk_bf16_f32 v13, v14, v15
    v_mul_f32 v16, v16, v199
    v_mul_f32 v17, v17, v199
    v_mfma_f32_16x16x32_bf16 v[24:27], a[36:39], a[84:87], v[24:27]
    ds_write_b64 v213, v[12:13] offset:96
    v_mul_f32 v18, v18, v199
    v_mul_f32 v19, v19, v199
    v_cvt_pk_bf16_f32 v16, v16, v17
    v_mfma_f32_16x16x32_bf16 v[24:27], a[40:43], a[88:91], v[24:27]
    s_mov_b32 s53, 36864
    ds_read_b128 v[168:171], v214 offset:0
    ds_read_b128 v[172:175], v214 offset:1152
    v_cvt_pk_bf16_f32 v17, v18, v19
    v_mfma_f32_16x16x32_bf16 v[24:27], a[44:47], a[92:95], v[24:27]
    ds_write_b64 v213, v[16:17] offset:2304
    v_mul_f32 v20, v20, v199
    v_mul_f32 v21, v21, v199
    v_mul_f32 v22, v22, v199
    v_mfma_f32_16x16x32_bf16 v[28:31], a[52:55], a[84:87], v[28:31]
    s_mov_b32 s54, 40960
    v_mul_f32 v23, v23, v199
    s_waitcnt lgkmcnt(4)
    v_add_f32 v104, v104, v105
    v_add_f32 v106, v106, v107
    v_mfma_f32_16x16x32_bf16 v[28:31], a[56:59], a[88:91], v[28:31]
    s_mov_b32 s55, 45056
    v_add_f32 v104, v104, v106
    v_cvt_pk_bf16_f32 v20, v20, v21
    v_mfma_f32_16x16x32_bf16 v[28:31], a[60:63], a[92:95], v[28:31]
    v_rcp_f32 v200, v104
    v_cvt_pk_bf16_f32 v21, v22, v23
    v_mfma_f32_16x16x32_bf16 v[32:35], a[4:7], a[100:103], v[32:35]
    ds_write_b64 v213, v[20:21] offset:2336
    s_waitcnt lgkmcnt(3)
    buffer_store_dwordx4 v[168:171], v219, s[24:27], s44 offen nt
    v_mul_f32 v24, v24, v199
    v_mul_f32 v25, v25, v199
    v_mul_f32 v26, v26, v199
    v_mfma_f32_16x16x32_bf16 v[32:35], a[8:11], a[104:107], v[32:35]
    ds_read_b128 a[116:119], v133 offset:3072
    s_waitcnt lgkmcnt(3)
    buffer_store_dwordx4 v[172:175], v219, s[24:27], s45 offen nt
    v_mul_f32 v27, v27, v199
    v_cvt_pk_bf16_f32 v24, v24, v25
    v_mfma_f32_16x16x32_bf16 v[32:35], a[12:15], a[108:111], v[32:35]
    ds_read_b128 a[120:123], v134 offset:3072
    v_cvt_pk_bf16_f32 v25, v26, v27
    v_mul_f32 v28, v28, v199
    v_mfma_f32_16x16x32_bf16 v[36:39], a[20:23], a[100:103], v[36:39]
    ds_read_b128 a[124:127], v135 offset:3072
    ds_write_b64 v213, v[24:25] offset:2368
    v_mul_f32 v29, v29, v199
    v_mul_f32 v30, v30, v199
    v_mfma_f32_16x16x32_bf16 v[36:39], a[24:27], a[104:107], v[36:39]
    ds_read_b128 v[108:111], v216 offset:2816
    v_mul_f32 v31, v31, v199
    v_cvt_pk_bf16_f32 v28, v28, v29
    v_mfma_f32_16x16x32_bf16 v[36:39], a[28:31], a[108:111], v[36:39]
    v_cvt_pk_bf16_f32 v29, v30, v31
    v_mul_f32 v32, v32, v200
    v_mul_f32 v33, v33, v200
    v_mfma_f32_16x16x32_bf16 v[40:43], a[36:39], a[100:103], v[40:43]
    ds_write_b64 v213, v[28:29] offset:2400
    v_mul_f32 v34, v34, v200
    v_mul_f32 v35, v35, v200
    v_cvt_pk_bf16_f32 v32, v32, v33
    v_mfma_f32_16x16x32_bf16 v[40:43], a[40:43], a[104:107], v[40:43]
    ds_read_b128 v[176:179], v214 offset:2304
    ds_read_b128 v[180:183], v214 offset:3456
    v_cvt_pk_bf16_f32 v33, v34, v35
    v_mfma_f32_16x16x32_bf16 v[40:43], a[44:47], a[108:111], v[40:43]
    ds_write_b64 v213, v[32:33] offset:4608
    v_mul_f32 v36, v36, v200
    v_mul_f32 v37, v37, v200
    v_mul_f32 v38, v38, v200
    v_mfma_f32_16x16x32_bf16 v[44:47], a[52:55], a[100:103], v[44:47]
    v_mul_f32 v39, v39, v200
    s_waitcnt lgkmcnt(4)
    v_add_f32 v108, v108, v109
    v_add_f32 v110, v110, v111
    v_mfma_f32_16x16x32_bf16 v[44:47], a[56:59], a[104:107], v[44:47]
    v_add_f32 v108, v108, v110
    v_cvt_pk_bf16_f32 v36, v36, v37
    v_mfma_f32_16x16x32_bf16 v[44:47], a[60:63], a[108:111], v[44:47]
    v_rcp_f32 v201, v108
    v_cvt_pk_bf16_f32 v37, v38, v39
    v_mfma_f32_16x16x32_bf16 v[48:51], a[4:7], a[116:119], v[48:51]
    ds_write_b64 v213, v[36:37] offset:4640
    s_waitcnt lgkmcnt(3)
    buffer_store_dwordx4 v[176:179], v219, s[24:27], s46 offen nt
    v_mul_f32 v40, v40, v200
    v_mul_f32 v41, v41, v200
    v_mul_f32 v42, v42, v200
    v_mfma_f32_16x16x32_bf16 v[48:51], a[8:11], a[120:123], v[48:51]
    ds_read_b128 a[132:135], v133 offset:4096
    s_waitcnt lgkmcnt(3)
    buffer_store_dwordx4 v[180:183], v219, s[24:27], s47 offen nt
    v_mul_f32 v43, v43, v200
    v_cvt_pk_bf16_f32 v40, v40, v41
    v_mfma_f32_16x16x32_bf16 v[48:51], a[12:15], a[124:127], v[48:51]
    ds_read_b128 a[136:139], v134 offset:4096
    v_cvt_pk_bf16_f32 v41, v42, v43
    v_mul_f32 v44, v44, v200
    v_mfma_f32_16x16x32_bf16 v[52:55], a[20:23], a[116:119], v[52:55]
    ds_read_b128 a[140:143], v135 offset:4096
    ds_write_b64 v213, v[40:41] offset:4672
    v_mul_f32 v45, v45, v200
    v_mul_f32 v46, v46, v200
    v_mfma_f32_16x16x32_bf16 v[52:55], a[24:27], a[120:123], v[52:55]
    ds_read_b128 v[112:115], v216 offset:3072
    v_mul_f32 v47, v47, v200
    v_cvt_pk_bf16_f32 v44, v44, v45
    v_mfma_f32_16x16x32_bf16 v[52:55], a[28:31], a[124:127], v[52:55]
    v_cvt_pk_bf16_f32 v45, v46, v47
    v_mul_f32 v48, v48, v201
    v_mul_f32 v49, v49, v201
    v_mfma_f32_16x16x32_bf16 v[56:59], a[36:39], a[116:119], v[56:59]
    ds_write_b64 v213, v[44:45] offset:4704
    v_mul_f32 v50, v50, v201
    v_mul_f32 v51, v51, v201
    v_cvt_pk_bf16_f32 v48, v48, v49
    v_mfma_f32_16x16x32_bf16 v[56:59], a[40:43], a[120:123], v[56:59]
    ds_read_b128 v[184:187], v214 offset:4608
    ds_read_b128 v[188:191], v214 offset:5760
    v_cvt_pk_bf16_f32 v49, v50, v51
    v_mfma_f32_16x16x32_bf16 v[56:59], a[44:47], a[124:127], v[56:59]
    ds_write_b64 v213, v[48:49] offset:6912
    v_mul_f32 v52, v52, v201
    v_mul_f32 v53, v53, v201
    v_mul_f32 v54, v54, v201
    v_mfma_f32_16x16x32_bf16 v[60:63], a[52:55], a[116:119], v[60:63]
    v_mul_f32 v55, v55, v201
    s_waitcnt lgkmcnt(4)
    v_add_f32 v112, v112, v113
    v_add_f32 v114, v114, v115
    v_mfma_f32_16x16x32_bf16 v[60:63], a[56:59], a[120:123], v[60:63]
    v_add_f32 v112, v112, v114
    v_cvt_pk_bf16_f32 v52, v52, v53
    v_mfma_f32_16x16x32_bf16 v[60:63], a[60:63], a[124:127], v[60:63]
    v_rcp_f32 v202, v112
    v_cvt_pk_bf16_f32 v53, v54, v55
    v_mfma_f32_16x16x32_bf16 v[64:67], a[4:7], a[132:135], v[64:67]
    ds_write_b64 v213, v[52:53] offset:6944
    s_waitcnt lgkmcnt(3)
    buffer_store_dwordx4 v[184:187], v219, s[24:27], s48 offen nt
    v_mul_f32 v56, v56, v201
    v_mul_f32 v57, v57, v201
    v_mul_f32 v58, v58, v201
    v_mfma_f32_16x16x32_bf16 v[64:67], a[8:11], a[136:139], v[64:67]
    ds_read_b128 a[148:151], v133 offset:5120
    s_waitcnt lgkmcnt(3)
    buffer_store_dwordx4 v[188:191], v219, s[24:27], s49 offen nt
    v_mul_f32 v59, v59, v201
    v_cvt_pk_bf16_f32 v56, v56, v57
    v_mfma_f32_16x16x32_bf16 v[64:67], a[12:15], a[140:143], v[64:67]
    ds_read_b128 a[152:155], v134 offset:5120
    v_cvt_pk_bf16_f32 v57, v58, v59
    v_mul_f32 v60, v60, v201
    v_mfma_f32_16x16x32_bf16 v[68:71], a[20:23], a[132:135], v[68:71]
    ds_read_b128 a[156:159], v135 offset:5120
    ds_write_b64 v213, v[56:57] offset:6976
    v_mul_f32 v61, v61, v201
    v_mul_f32 v62, v62, v201
    v_mfma_f32_16x16x32_bf16 v[68:71], a[24:27], a[136:139], v[68:71]
    ds_read_b128 v[116:119], v216 offset:3328
    v_mul_f32 v63, v63, v201
    v_cvt_pk_bf16_f32 v60, v60, v61
    v_mfma_f32_16x16x32_bf16 v[68:71], a[28:31], a[140:143], v[68:71]
    v_cvt_pk_bf16_f32 v61, v62, v63
    v_mul_f32 v64, v64, v202
    v_mul_f32 v65, v65, v202
    v_mfma_f32_16x16x32_bf16 v[72:75], a[36:39], a[132:135], v[72:75]
    ds_write_b64 v213, v[60:61] offset:7008
    v_mul_f32 v66, v66, v202
    v_mul_f32 v67, v67, v202
    v_cvt_pk_bf16_f32 v64, v64, v65
    v_mfma_f32_16x16x32_bf16 v[72:75], a[40:43], a[136:139], v[72:75]
    ds_read_b128 v[168:171], v214 offset:6912
    ds_read_b128 v[172:175], v214 offset:8064
    v_cvt_pk_bf16_f32 v65, v66, v67
    v_mfma_f32_16x16x32_bf16 v[72:75], a[44:47], a[140:143], v[72:75]
    ds_write_b64 v213, v[64:65] offset:9216
    v_mul_f32 v68, v68, v202
    v_mul_f32 v69, v69, v202
    v_mul_f32 v70, v70, v202
    v_mfma_f32_16x16x32_bf16 v[76:79], a[52:55], a[132:135], v[76:79]
    v_mul_f32 v71, v71, v202
    s_waitcnt lgkmcnt(4)
    v_add_f32 v116, v116, v117
    v_add_f32 v118, v118, v119
    v_mfma_f32_16x16x32_bf16 v[76:79], a[56:59], a[136:139], v[76:79]
    v_add_f32 v116, v116, v118
    v_cvt_pk_bf16_f32 v68, v68, v69
    v_mfma_f32_16x16x32_bf16 v[76:79], a[60:63], a[140:143], v[76:79]
    v_rcp_f32 v203, v116
    v_cvt_pk_bf16_f32 v69, v70, v71
    v_mfma_f32_16x16x32_bf16 v[80:83], a[4:7], a[148:151], v[80:83]
    ds_write_b64 v213, v[68:69] offset:9248
    s_waitcnt lgkmcnt(3)
    buffer_store_dwordx4 v[168:171], v219, s[24:27], s50 offen nt
    v_mul_f32 v72, v72, v202
    v_mul_f32 v73, v73, v202
    v_mul_f32 v74, v74, v202
    v_mfma_f32_16x16x32_bf16 v[80:83], a[8:11], a[152:155], v[80:83]
    s_waitcnt lgkmcnt(2)
    buffer_store_dwordx4 v[172:175], v219, s[24:27], s51 offen nt
    v_mul_f32 v75, v75, v202
    v_cvt_pk_bf16_f32 v72, v72, v73
    v_mfma_f32_16x16x32_bf16 v[80:83], a[12:15], a[156:159], v[80:83]
    v_cvt_pk_bf16_f32 v73, v74, v75
    v_mul_f32 v76, v76, v202
    v_mul_f32 v77, v77, v202
    v_mfma_f32_16x16x32_bf16 v[84:87], a[20:23], a[148:151], v[84:87]
    ds_write_b64 v213, v[72:73] offset:9280
    v_mul_f32 v78, v78, v202
    v_mul_f32 v79, v79, v202
    v_cvt_pk_bf16_f32 v76, v76, v77
    v_mfma_f32_16x16x32_bf16 v[84:87], a[24:27], a[152:155], v[84:87]
    v_cvt_pk_bf16_f32 v77, v78, v79
    v_mfma_f32_16x16x32_bf16 v[84:87], a[28:31], a[156:159], v[84:87]
    ds_write_b64 v213, v[76:77] offset:9312
    v_mul_f32 v80, v80, v203
    v_mul_f32 v81, v81, v203
    v_mul_f32 v82, v82, v203
    v_mfma_f32_16x16x32_bf16 v[88:91], a[36:39], a[148:151], v[88:91]
    ds_read_b128 v[176:179], v214 offset:9216
    ds_read_b128 v[180:183], v214 offset:10368
    v_mul_f32 v83, v83, v203
    v_cvt_pk_bf16_f32 v80, v80, v81
    v_mfma_f32_16x16x32_bf16 v[88:91], a[40:43], a[152:155], v[88:91]
    v_cvt_pk_bf16_f32 v81, v82, v83
    v_mfma_f32_16x16x32_bf16 v[88:91], a[44:47], a[156:159], v[88:91]
    ds_write_b64 v213, v[80:81] offset:11520
    v_mul_f32 v84, v84, v203
    v_mul_f32 v85, v85, v203
    v_mul_f32 v86, v86, v203
    v_mfma_f32_16x16x32_bf16 v[92:95], a[52:55], a[148:151], v[92:95]
    v_mul_f32 v87, v87, v203
    v_cvt_pk_bf16_f32 v84, v84, v85
    v_mfma_f32_16x16x32_bf16 v[92:95], a[56:59], a[152:155], v[92:95]
    v_cvt_pk_bf16_f32 v85, v86, v87
    v_mfma_f32_16x16x32_bf16 v[92:95], a[60:63], a[156:159], v[92:95]
    ds_write_b64 v213, v[84:85] offset:11552
    s_waitcnt lgkmcnt(3)
    buffer_store_dwordx4 v[176:179], v219, s[24:27], s52 offen nt
    v_mul_f32 v88, v88, v203
    v_mul_f32 v89, v89, v203
    v_mul_f32 v90, v90, v203
    s_waitcnt lgkmcnt(2)
    buffer_store_dwordx4 v[180:183], v219, s[24:27], s53 offen nt
    v_mul_f32 v91, v91, v203
    v_cvt_pk_bf16_f32 v88, v88, v89
    s_nop 7
    v_cvt_pk_bf16_f32 v89, v90, v91
    v_mul_f32 v92, v92, v203
    v_mul_f32 v93, v93, v203
    ds_write_b64 v213, v[88:89] offset:11584
    v_mul_f32 v94, v94, v203
    v_mul_f32 v95, v95, v203
    v_cvt_pk_bf16_f32 v92, v92, v93
    v_cvt_pk_bf16_f32 v93, v94, v95
    ds_write_b64 v213, v[92:93] offset:11616
    ds_read_b128 v[184:187], v214 offset:11520
    ds_read_b128 v[188:191], v214 offset:12672
    s_waitcnt lgkmcnt(1)
    buffer_store_dwordx4 v[184:187], v219, s[24:27], s54 offen nt
    s_waitcnt lgkmcnt(0)
    buffer_store_dwordx4 v[188:191], v219, s[24:27], s55 offen nt
L_end:
    s_endpgm
L_switch:
    s_mov_b32 s16, s20
    s_mov_b32 s17, s21
    v_add_u32 v213, s7, v214
    s_mov_b32 s7, 0x40000000
    s_sub_u32 s76, s36, s40
    v_lshrrev_b32 v222, 5, v220
    v_lshl_add_u32 v222, v222, 5, s76
    s_add_u32 s77, s28, 0
    s_and_b32 s77, s77, 3
    s_lshl_b32 s77, s77, 14
    s_xor_b32 s77, s77, s83
    s_add_u32 s44, s77, 4096
    s_add_u32 s45, s77, 7136
    s_xor_b32 s76, s77, 8192
    s_add_u32 s46, s76, 1984
    s_add_u32 s47, s76, 5024
    v_add_u32 v253, v224, v222
    s_add_u32 s77, s28, 1
    s_and_b32 s77, s77, 3
    s_mul_i32 s79, s77, 6144
    s_lshl_b32 s77, s77, 14
    s_xor_b32 s77, s77, s83
    s_add_u32 s48, s77, 4096
    s_add_u32 s49, s77, 7136
    s_xor_b32 s76, s77, 8192
    s_add_u32 s50, s76, 1984
    s_add_u32 s51, s76, 5024
    v_add_u32 v254, v225, v222
    s_add_u32 s77, s28, 2
    s_and_b32 s77, s77, 3
    s_mul_i32 s80, s77, 6144
    s_lshl_b32 s77, s77, 14
    s_xor_b32 s77, s77, s83
    s_add_u32 s52, s77, 4096
    s_add_u32 s53, s77, 7136
    s_xor_b32 s76, s77, 8192
    s_add_u32 s54, s76, 1984
    s_add_u32 s55, s76, 5024
    v_add_u32 v255, v226, v222
    s_add_u32 s77, s28, 3
    s_and_b32 s77, s77, 3
    s_mul_i32 s81, s77, 6144
    s_lshl_b32 s77, s77, 14
    s_xor_b32 s77, s77, s83
    s_add_u32 s56, s77, 4096
    s_add_u32 s57, s77, 7136
    s_xor_b32 s76, s77, 8192
    s_add_u32 s58, s76, 1984
    s_add_u32 s59, s76, 5024
    v_add_u32 v221, v227, v222
    s_branch L_loop
L_code_end:
L_notify:
    v_mov_b32 v218, 1
    ds_write_b32 v217, v218
    s_waitcnt lgkmcnt(0)
    s_branch L_notified
L_notify0:
    v_mov_b32 v218, 1
    ds_write_b32 v217, v218
    s_waitcnt lgkmcnt(0)
    s_branch L_notified0
L_slow:
    s_waitcnt lgkmcnt(0)
    s_barrier
    s_nop 7
    v_max3_f32 v240, v96, v97, v98
    v_max3_f32 v241, v104, v105, v106
    v_max3_f32 v240, v240, v99, v100
    v_max3_f32 v241, v241, v107, v108
    v_max3_f32 v240, v240, v101, v102
    v_max3_f32 v241, v241, v109, v110
    v_max_f32 v240, v240, v103
    v_max_f32 v241, v241, v111
    s_nop 1
    v_permlane32_swap_b32 v240, v241
    v_max_f32 v240, v240, v241
    v_mov_b32 v242, v240
    s_nop 1
    v_permlane16_swap_b32 v240, v242
    v_max_f32 v240, v240, v242
    v_mul_f32 v240, s32, v240
    ds_write_b32 v215, v240 offset:0
    v_max3_f32 v240, v112, v113, v114
    v_max3_f32 v241, v120, v121, v122
    v_max3_f32 v240, v240, v115, v116
    v_max3_f32 v241, v241, v123, v124
    v_max3_f32 v240, v240, v117, v118
    v_max3_f32 v241, v241, v125, v126
    v_max_f32 v240, v240, v119
    v_max_f32 v241, v241, v127
    s_nop 1
    v_permlane32_swap_b32 v240, v241
    v_max_f32 v240, v240, v241
    v_mov_b32 v242, v240
    s_nop 1
    v_permlane16_swap_b32 v240, v242
    v_max_f32 v240, v240, v242
    v_mul_f32 v240, s32, v240
    ds_write_b32 v215, v240 offset:512
    v_max3_f32 v240, v128, v129, v130
    v_max3_f32 v241, v136, v137, v138
    v_max3_f32 v240, v240, v131, v132
    v_max3_f32 v241, v241, v139, v140
    v_max3_f32 v240, v240, v133, v134
    v_max3_f32 v241, v241, v141, v142
    v_max_f32 v240, v240, v135
    v_max_f32 v241, v241, v143
    s_nop 1
    v_permlane32_swap_b32 v240, v241
    v_max_f32 v240, v240, v241
    v_mov_b32 v242, v240
    s_nop 1
    v_permlane16_swap_b32 v240, v242
    v_max_f32 v240, v240, v242
    v_mul_f32 v240, s32, v240
    ds_write_b32 v215, v240 offset:1024
    s_waitcnt lgkmcnt(0)
    s_barrier
    v_mov_b32 v218, 0
    ds_write_b32 v217, v218
    ds_read_b128 v[168:171], v216 offset:0
    ds_read_b128 v[172:175], v216 offset:256
    ds_read_b128 v[176:179], v216 offset:512
    ds_read_b128 v[180:183], v216 offset:768
    ds_read_b128 v[184:187], v216 offset:1024
    ds_read_b128 v[188:191], v216 offset:1280
    s_waitcnt lgkmcnt(0)
    v_max3_f32 v168, v168, v169, v170
    v_max3_f32 v172, v172, v173, v174
    v_max3_f32 v176, v176, v177, v178
    v_max3_f32 v180, v180, v181, v182
    v_max3_f32 v184, v184, v185, v186
    v_max3_f32 v188, v188, v189, v190
    v_max3_f32 v168, v168, v171, v192
    v_max3_f32 v172, v172, v175, v193
    v_max3_f32 v176, v176, v179, v194
    v_max3_f32 v180, v180, v183, v195
    v_max3_f32 v184, v184, v187, v196
    v_max3_f32 v188, v188, v191, v197
    v_sub_f32 v240, v192, v168
    v_sub_f32 v241, v193, v172
    v_sub_f32 v242, v194, v176
    v_sub_f32 v243, v195, v180
    v_sub_f32 v244, v196, v184
    v_sub_f32 v245, v197, v188
    v_exp_f32 v240, v240
    v_exp_f32 v241, v241
    v_exp_f32 v242, v242
    v_exp_f32 v243, v243
    v_exp_f32 v244, v244
    v_exp_f32 v245, v245
    v_mov_b32 v192, v168
    v_mov_b32 v193, v172
    v_mov_b32 v194, v176
    v_mov_b32 v195, v180
    v_mov_b32 v196, v184
    v_mov_b32 v197, v188
    v_mul_f32 v198, v198, v240
    v_mul_f32 v199, v199, v241
    v_mul_f32 v200, v200, v242
    v_mul_f32 v201, v201, v243
    v_mul_f32 v202, v202, v244
    v_mul_f32 v203, v203, v245
    v_mul_f32 v0, v0, v240
    v_mul_f32 v1, v1, v240
    v_mul_f32 v2, v2, v240
    v_mul_f32 v3, v3, v240
    v_mul_f32 v4, v4, v240
    v_mul_f32 v5, v5, v240
    v_mul_f32 v6, v6, v240
    v_mul_f32 v7, v7, v240
    v_mul_f32 v8, v8, v240
    v_mul_f32 v9, v9, v240
    v_mul_f32 v10, v10, v240
    v_mul_f32 v11, v11, v240
    v_mul_f32 v12, v12, v240
    v_mul_f32 v13, v13, v240
    v_mul_f32 v14, v14, v240
    v_mul_f32 v15, v15, v240
    v_mul_f32 v16, v16, v241
    v_mul_f32 v17, v17, v241
    v_mul_f32 v18, v18, v241
    v_mul_f32 v19, v19, v241
    v_mul_f32 v20, v20, v241
    v_mul_f32 v21, v21, v241
    v_mul_f32 v22, v22, v241
    v_mul_f32 v23, v23, v241
    v_mul_f32 v24, v24, v241
    v_mul_f32 v25, v25, v241
    v_mul_f32 v26, v26, v241
    v_mul_f32 v27, v27, v241
    v_mul_f32 v28, v28, v241
    v_mul_f32 v29, v29, v241
    v_mul_f32 v30, v30, v241
    v_mul_f32 v31, v31, v241
    v_mul_f32 v32, v32, v242
    v_mul_f32 v33, v33, v242
    v_mul_f32 v34, v34, v242
    v_mul_f32 v35, v35, v242
    v_mul_f32 v36, v36, v242
    v_mul_f32 v37, v37, v242
    v_mul_f32 v38, v38, v242
    v_mul_f32 v39, v39, v242
    v_mul_f32 v40, v40, v242
    v_mul_f32 v41, v41, v242
    v_mul_f32 v42, v42, v242
    v_mul_f32 v43, v43, v242
    v_mul_f32 v44, v44, v242
    v_mul_f32 v45, v45, v242
    v_mul_f32 v46, v46, v242
    v_mul_f32 v47, v47, v242
    v_mul_f32 v48, v48, v243
    v_mul_f32 v49, v49, v243
    v_mul_f32 v50, v50, v243
    v_mul_f32 v51, v51, v243
    v_mul_f32 v52, v52, v243
    v_mul_f32 v53, v53, v243
    v_mul_f32 v54, v54, v243
    v_mul_f32 v55, v55, v243
    v_mul_f32 v56, v56, v243
    v_mul_f32 v57, v57, v243
    v_mul_f32 v58, v58, v243
    v_mul_f32 v59, v59, v243
    v_mul_f32 v60, v60, v243
    v_mul_f32 v61, v61, v243
    v_mul_f32 v62, v62, v243
    v_mul_f32 v63, v63, v243
    v_mul_f32 v64, v64, v244
    v_mul_f32 v65, v65, v244
    v_mul_f32 v66, v66, v244
    v_mul_f32 v67, v67, v244
    v_mul_f32 v68, v68, v244
    v_mul_f32 v69, v69, v244
    v_mul_f32 v70, v70, v244
    v_mul_f32 v71, v71, v244
    v_mul_f32 v72, v72, v244
    v_mul_f32 v73, v73, v244
    v_mul_f32 v74, v74, v244
    v_mul_f32 v75, v75, v244
    v_mul_f32 v76, v76, v244
    v_mul_f32 v77, v77, v244
    v_mul_f32 v78, v78, v244
    v_mul_f32 v79, v79, v244
    v_mul_f32 v80, v80, v245
    v_mul_f32 v81, v81, v245
    v_mul_f32 v82, v82, v245
    v_mul_f32 v83, v83, v245
    v_mul_f32 v84, v84, v245
    v_mul_f32 v85, v85, v245
    v_mul_f32 v86, v86, v245
    v_mul_f32 v87, v87, v245
    v_mul_f32 v88, v88, v245
    v_mul_f32 v89, v89, v245
    v_mul_f32 v90, v90, v245
    v_mul_f32 v91, v91, v245
    v_mul_f32 v92, v92, v245
    v_mul_f32 v93, v93, v245
    v_mul_f32 v94, v94, v245
    v_mul_f32 v95, v95, v245
    v_fma_f32 v228, v96, s32, -v192
    v_fma_f32 v229, v97, s32, -v192
    v_exp_f32 v228, v228
    v_fma_f32 v230, v98, s32, -v192
    v_exp_f32 v229, v229
    v_fma_f32 v231, v99, s32, -v192
    v_exp_f32 v230, v230
    v_add_f32 v204, v228, v229
    v_cvt_pk_bf16_f32 v144, v228, v229
    v_fma_f32 v232, v100, s32, -v192
    v_exp_f32 v231, v231
    v_add_f32 v204, v204, v230
    v_fma_f32 v233, v101, s32, -v192
    v_exp_f32 v232, v232
    v_add_f32 v204, v204, v231
    v_cvt_pk_bf16_f32 v145, v230, v231
    v_fma_f32 v234, v102, s32, -v192
    v_exp_f32 v233, v233
    v_add_f32 v204, v204, v232
    v_fma_f32 v235, v103, s32, -v192
    v_exp_f32 v234, v234
    v_add_f32 v204, v204, v233
    v_cvt_pk_bf16_f32 v146, v232, v233
    v_fma_f32 v236, v104, s32, -v193
    v_exp_f32 v235, v235
    v_add_f32 v204, v204, v234
    v_fma_f32 v237, v105, s32, -v193
    v_exp_f32 v236, v236
    v_add_f32 v204, v204, v235
    v_cvt_pk_bf16_f32 v147, v234, v235
    v_fma_f32 v238, v106, s32, -v193
    v_exp_f32 v237, v237
    v_fma_f32 v239, v107, s32, -v193
    v_exp_f32 v238, v238
    v_add_f32 v205, v236, v237
    v_cvt_pk_bf16_f32 v148, v236, v237
    v_fma_f32 v228, v108, s32, -v193
    v_exp_f32 v239, v239
    v_add_f32 v205, v205, v238
    v_fma_f32 v229, v109, s32, -v193
    v_exp_f32 v228, v228
    v_add_f32 v205, v205, v239
    v_cvt_pk_bf16_f32 v149, v238, v239
    v_fma_f32 v230, v110, s32, -v193
    v_exp_f32 v229, v229
    v_add_f32 v205, v205, v228
    v_fma_f32 v231, v111, s32, -v193
    v_exp_f32 v230, v230
    v_add_f32 v205, v205, v229
    v_cvt_pk_bf16_f32 v150, v228, v229
    v_fma_f32 v232, v112, s32, -v194
    v_exp_f32 v231, v231
    v_add_f32 v205, v205, v230
    v_fma_f32 v233, v113, s32, -v194
    v_exp_f32 v232, v232
    v_add_f32 v205, v205, v231
    v_cvt_pk_bf16_f32 v151, v230, v231
    v_fma_f32 v234, v114, s32, -v194
    v_exp_f32 v233, v233
    v_fma_f32 v235, v115, s32, -v194
    v_exp_f32 v234, v234
    v_add_f32 v206, v232, v233
    v_cvt_pk_bf16_f32 v152, v232, v233
    v_fma_f32 v236, v116, s32, -v194
    v_exp_f32 v235, v235
    v_add_f32 v206, v206, v234
    v_fma_f32 v237, v117, s32, -v194
    v_exp_f32 v236, v236
    v_add_f32 v206, v206, v235
    v_cvt_pk_bf16_f32 v153, v234, v235
    v_fma_f32 v238, v118, s32, -v194
    v_exp_f32 v237, v237
    v_add_f32 v206, v206, v236
    v_fma_f32 v239, v119, s32, -v194
    v_exp_f32 v238, v238
    v_add_f32 v206, v206, v237
    v_cvt_pk_bf16_f32 v154, v236, v237
    v_fma_f32 v228, v120, s32, -v195
    v_exp_f32 v239, v239
    v_add_f32 v206, v206, v238
    v_fma_f32 v229, v121, s32, -v195
    v_exp_f32 v228, v228
    v_add_f32 v206, v206, v239
    v_cvt_pk_bf16_f32 v155, v238, v239
    v_fma_f32 v230, v122, s32, -v195
    v_exp_f32 v229, v229
    v_fma_f32 v231, v123, s32, -v195
    v_exp_f32 v230, v230
    v_add_f32 v207, v228, v229
    v_cvt_pk_bf16_f32 v156, v228, v229
    v_fma_f32 v232, v124, s32, -v195
    v_exp_f32 v231, v231
    v_add_f32 v207, v207, v230
    v_fma_f32 v233, v125, s32, -v195
    v_exp_f32 v232, v232
    v_add_f32 v207, v207, v231
    v_cvt_pk_bf16_f32 v157, v230, v231
    v_fma_f32 v234, v126, s32, -v195
    v_exp_f32 v233, v233
    v_add_f32 v207, v207, v232
    v_fma_f32 v235, v127, s32, -v195
    v_exp_f32 v234, v234
    v_add_f32 v207, v207, v233
    v_cvt_pk_bf16_f32 v158, v232, v233
    v_fma_f32 v236, v128, s32, -v196
    v_exp_f32 v235, v235
    v_add_f32 v207, v207, v234
    v_fma_f32 v237, v129, s32, -v196
    v_exp_f32 v236, v236
    v_add_f32 v207, v207, v235
    v_cvt_pk_bf16_f32 v159, v234, v235
    v_fma_f32 v238, v130, s32, -v196
    v_exp_f32 v237, v237
    v_fma_f32 v239, v131, s32, -v196
    v_exp_f32 v238, v238
    v_add_f32 v208, v236, v237
    v_cvt_pk_bf16_f32 v160, v236, v237
    v_fma_f32 v228, v132, s32, -v196
    v_exp_f32 v239, v239
    v_add_f32 v208, v208, v238
    v_fma_f32 v229, v133, s32, -v196
    v_exp_f32 v228, v228
    v_add_f32 v208, v208, v239
    v_cvt_pk_bf16_f32 v161, v238, v239
    v_fma_f32 v230, v134, s32, -v196
    v_exp_f32 v229, v229
    v_add_f32 v208, v208, v228
    v_fma_f32 v231, v135, s32, -v196
    v_exp_f32 v230, v230
    v_add_f32 v208, v208, v229
    v_cvt_pk_bf16_f32 v162, v228, v229
    v_fma_f32 v232, v136, s32, -v197
    v_exp_f32 v231, v231
    v_add_f32 v208, v208, v230
    v_fma_f32 v233, v137, s32, -v197
    v_exp_f32 v232, v232
    v_add_f32 v208, v208, v231
    v_cvt_pk_bf16_f32 v163, v230, v231
    v_fma_f32 v234, v138, s32, -v197
    v_exp_f32 v233, v233
    v_fma_f32 v235, v139, s32, -v197
    v_exp_f32 v234, v234
    v_add_f32 v209, v232, v233
    v_cvt_pk_bf16_f32 v164, v232, v233
    v_fma_f32 v236, v140, s32, -v197
    v_exp_f32 v235, v235
    v_add_f32 v209, v209, v234
    v_fma_f32 v237, v141, s32, -v197
    v_exp_f32 v236, v236
    v_add_f32 v209, v209, v235
    v_cvt_pk_bf16_f32 v165, v234, v235
    v_fma_f32 v238, v142, s32, -v197
    v_exp_f32 v237, v237
    v_add_f32 v209, v209, v236
    v_fma_f32 v239, v143, s32, -v197
    v_exp_f32 v238, v238
    v_add_f32 v209, v209, v237
    v_cvt_pk_bf16_f32 v166, v236, v237
    v_exp_f32 v239, v239
    v_add_f32 v209, v209, v238
    v_add_f32 v209, v209, v239
    v_cvt_pk_bf16_f32 v167, v238, v239
    s_cmp_lt_u32 s31, 6
    s_branch L_slow_ret
.section .rodata,"a"
.p2align 6
.amdhsa_kernel standalone__gqa_softmax__near_ridge_kernel
  .amdhsa_next_free_vgpr 512
  .amdhsa_next_free_sgpr 102
  .amdhsa_accum_offset 256
  .amdhsa_group_segment_fixed_size 0
  .amdhsa_kernarg_size 48
  .amdhsa_user_sgpr_count 2
  .amdhsa_user_sgpr_kernarg_segment_ptr 1
  .amdhsa_system_sgpr_workgroup_id_x 1
.end_amdhsa_kernel
```
